```python
import torch

def _softmax(x, axis=-1):
    return torch.softmax(x, dim=axis)
def _gelu(x):
    return torch.nn.functional.gelu(x, approximate="tanh")
def _silu(x):
    return torch.nn.functional.silu(x)
def _sigmoid(x):
    return torch.sigmoid(x)
def _layernorm(x, axis=-1, eps=1e-5):
    m = x.mean(dim=axis, keepdim=True)
    v = x.var(dim=axis, keepdim=True, unbiased=False)
    return (x - m) / torch.sqrt(v + eps)
def _scatter_add(tgt, idx, src, axis=0):
    return tgt.clone().index_add_(axis, idx, src)
def _segment_sum(src, seg, n):
    out = torch.zeros((n,) + src.shape[1:], dtype=src.dtype)
    return out.index_add_(0, seg, src)
def _pad(x, pw):
    flat = tuple(v for pair in reversed(pw) for v in pair)
    return torch.nn.functional.pad(x, flat)

kernel_name = 'gated_mix__gqa_block_cached__swiglu_ffn__decode'

def setup_inputs():

    _w = (lambda a: (lambda t: t.to(torch.bfloat16) if t.is_floating_point() else t)(torch.as_tensor(a)))
    def _A_setup():
        B, Sq, D = 2, 1, 576
        Hq, Hkv, Sk, Dh = 32, 16, 4096, 128
        assert Hq % Hkv == 0, (Hq, Hkv)
        return {
            "x": _w((lambda *s: torch.randn(*s, dtype=torch.bfloat16) * 0.05)(B, Sq, D)),
            "k_cache": _w((lambda *s: torch.randn(*s, dtype=torch.bfloat16) * 6.4)(B, Hkv, Sk, Dh)),
            "v_cache": _w((lambda *s: torch.randn(*s, dtype=torch.bfloat16) * 0.8)(B, Hkv, Sk, Dh)),
            "wq": _w((lambda *s: torch.randn(*s, dtype=torch.bfloat16) * 6.4)(D, Hq * Dh) * (D ** -0.5)),
            "wo": _w((lambda *s: torch.randn(*s, dtype=torch.bfloat16) * 0.8)(Hq * Dh, D) * ((Hq * Dh) ** -0.5)),
        }
    _A_in = _A_setup()

    def _B_setup():
        B, S, D, F = 2, 1, 576, 4608
        return {
            "x": _w((lambda *s: torch.randn(*s, dtype=torch.bfloat16) * 0.05)(B, S, D)),
            "w_gate": _w((lambda *s: torch.randn(*s, dtype=torch.bfloat16) * 0.2)(D, F)),
            "w_up": _w((lambda *s: torch.randn(*s, dtype=torch.bfloat16) * 0.2)(D, F)),
            "w_down": _w((lambda *s: torch.randn(*s, dtype=torch.bfloat16) * 0.2)(F, D)),
        }
    _B_in = _B_setup()

    return {
        "A_x": _A_in["x"],
        "A_k_cache": _A_in["k_cache"],
        "A_v_cache": _A_in["v_cache"],
        "A_wq": _A_in["wq"],
        "A_wo": _A_in["wo"],
        "B_x": _B_in["x"],
        "B_w_gate": _B_in["w_gate"],
        "B_w_up": _B_in["w_up"],
        "B_w_down": _B_in["w_down"],
        "gate_w": _w((lambda *s: torch.randn(*s, dtype=torch.bfloat16) * 0.05)(576) * 16.0),
    }

def reference(A_x, A_k_cache, A_v_cache, A_wq, A_wo, B_x, B_w_gate, B_w_up, B_w_down, gate_w):
    def _A_ref(x, k_cache, v_cache, wq, wo):
        B, Sq, D = x.shape
        Hq, Dh = 32, 128
        Hkv = k_cache.shape[1]
        rep = Hq // Hkv
        q = (lambda x, *d: x.permute(*d))((x @ wq).reshape(B, Sq, Hq, Dh), 0, 2, 1, 3)
        k = (lambda x, n, axis: torch.repeat_interleave(x, n, dim=axis))(k_cache, rep, axis=1)
        v = (lambda x, n, axis: torch.repeat_interleave(x, n, dim=axis))(v_cache, rep, axis=1)
        scores = torch.einsum("bhqd,bhkd->bhqk", q, k) * (Dh ** -0.5)
        p = _softmax(scores, axis=-1)
        o = torch.einsum("bhqk,bhkd->bhqd", p, v)
        return (lambda x, *d: x.permute(*d))(o, 0, 2, 1, 3).reshape(B, Sq, Hq * Dh) @ wo

    def _B_ref(x, w_gate, w_up, w_down):
        g = _silu(x @ w_gate)
        u = x @ w_up
        return (g * u) @ w_down

    x = A_x
    g = _sigmoid((x * gate_w).sum(-1, keepdims=True))
    a = _A_ref(x, A_k_cache, A_v_cache, A_wq, A_wo)
    b = _B_ref(x, B_w_gate, B_w_up, B_w_down)
    return g * a + (1 - g) * b
```

```asm
; @launch grid=(256,1,1) block=(768,1,1) lds=30784
.amdgcn_target "amdgcn-amd-amdhsa--gfx950"
.text
.globl gated_mix__gqa_block_cached__swiglu_ffn__decode_kernel
.p2align 8
.type gated_mix__gqa_block_cached__swiglu_ffn__decode_kernel,@function
gated_mix__gqa_block_cached__swiglu_ffn__decode_kernel:
  s_cmp_ge_u32 s2, 256
  s_cbranch_scc1 L_end
  s_load_dwordx16 s[4:19], s[0:1], 0
  s_load_dwordx8 s[20:27], s[0:1], 64
  s_load_dwordx2 s[28:29], s[0:1], 96
  v_lshrrev_b32 v1, 6, v0
  v_and_b32 v0, 63, v0
  v_readfirstlane_b32 s3, v1
  s_lshr_b32 s84, s2, 4
  s_and_b32 s85, s2, 15
  s_movk_i32 s31, 0x3ff
  s_waitcnt lgkmcnt(0)
  s_mov_b32 s32, s6
  s_mov_b32 s33, s7
  s_mov_b32 s34, 33554432
  s_mov_b32 s35, 0x00020000
  s_mov_b32 s36, s8
  s_mov_b32 s37, s9
  s_mov_b32 s38, 33554432
  s_mov_b32 s39, 0x00020000
  s_mov_b32 s40, s10
  s_mov_b32 s41, s11
  s_mov_b32 s42, 4718592
  s_mov_b32 s43, 0x00020000
  s_mov_b32 s44, s12
  s_mov_b32 s45, s13
  s_mov_b32 s46, 4718592
  s_mov_b32 s47, 0x00020000
  s_mov_b32 s48, s16
  s_mov_b32 s49, s17
  s_mov_b32 s50, 5308416
  s_mov_b32 s51, 0x00020000
  s_mov_b32 s52, s18
  s_mov_b32 s53, s19
  s_mov_b32 s54, 5308416
  s_mov_b32 s55, 0x00020000
  s_mov_b32 s56, s20
  s_mov_b32 s57, s21
  s_mov_b32 s58, 5308416
  s_mov_b32 s59, 0x00020000
  s_mov_b32 s60, s28
  s_mov_b32 s61, s29
  s_mov_b32 s62, 3342352
  s_mov_b32 s63, 0x00020000
  s_mov_b32 s64, s24
  s_mov_b32 s65, s25
  s_mov_b32 s66, 2304
  s_mov_b32 s67, 0x00020000
  s_mov_b32 s68, s4
  s_mov_b32 s69, s5
  s_mov_b32 s70, 2304
  s_mov_b32 s71, 0x00020000
  s_mov_b32 s72, s22
  s_mov_b32 s73, s23
  s_mov_b32 s74, 1152
  s_mov_b32 s75, 0x00020000
  s_add_u32 s76, s28, 3342336
  s_addc_u32 s77, s29, 0
  s_cmp_lt_u32 s3, 8
  s_cbranch_scc1 L_kv
L_aux:
  s_sub_u32 s86, s3, 8
  s_setprio 3
  s_lshr_b32 s88, s85, 2
  s_mul_i32 s88, s88, 144
  s_mul_i32 s89, s86, 36
  s_add_u32 s88, s88, s89
  s_lshl_b32 s87, s88, 1
  v_lshlrev_b32 v138, 1, v0
  buffer_load_ushort v144, v138, s[68:71], s87 offen
  buffer_load_ushort v145, v138, s[68:71], s87 offen offset:1152
  s_mul_i32 s90, s85, 36
  s_add_u32 s90, s90, s86
  s_lshl_b32 s87, s90, 1
  v_and_b32 v138, 15, v0
  v_lshlrev_b32 v138, 3, v138
  v_lshrrev_b32 v139, 4, v0
  v_mul_u32_u24 v139, 1152, v139
  v_add_u32 v138, v138, v139
  buffer_load_ushort v143, v138, s[68:71], s87 offen
  v_lshrrev_b32 v138, 3, v0
  v_lshlrev_b32 v139, 13, v138
  v_and_b32 v140, 7, v0
  v_lshl_add_u32 v139, v140, 4, v139
  v_mov_b32 v140, 2147483648
  v_cmp_gt_u32 vcc, 32, v0
  s_lshl_b32 s91, s88, 13
  s_lshl_b32 s92, s84, 9
  v_cndmask_b32 v141, v140, v139, vcc
  s_add_u32 s91, s91, s92
  s_and_b32 s92, s85, 3
  s_lshl_b32 s92, s92, 7
  s_add_u32 s91, s91, s92
  buffer_load_dwordx4 v[4:7], v139, s[40:43], s91 offen nt
  s_add_u32 s91, s91, 65536
  buffer_load_dwordx4 v[8:11], v139, s[40:43], s91 offen nt
  s_add_u32 s91, s91, 65536
  buffer_load_dwordx4 v[12:15], v139, s[40:43], s91 offen nt
  s_add_u32 s91, s91, 65536
  buffer_load_dwordx4 v[16:19], v139, s[40:43], s91 offen nt
  s_add_u32 s91, s91, 65536
  buffer_load_dwordx4 v[20:23], v141, s[40:43], s91 offen nt
  v_lshlrev_b32 v142, 4, v0
  v_cmp_gt_u32 vcc, 36, v0
  v_mov_b32 v3, 0
  v_mov_b32 v137, 1
  v_cndmask_b32 v2, v140, v142, vcc
  s_mul_i32 s92, s90, 9216
  s_mul_i32 s93, s84, 576
  s_add_u32 s92, s92, s93
  s_mov_b32 s93, s92
  buffer_load_dwordx4 v[24:27], v2, s[48:51], s92 offen nt
  s_add_u32 s92, s92, 36864
  buffer_load_dwordx4 v[28:31], v2, s[48:51], s92 offen nt
  s_add_u32 s92, s92, 36864
  buffer_load_dwordx4 v[32:35], v2, s[48:51], s92 offen nt
  s_add_u32 s92, s92, 36864
  buffer_load_dwordx4 v[36:39], v2, s[48:51], s92 offen nt
  s_add_u32 s92, s92, 36864
  buffer_load_dwordx4 v[40:43], v2, s[48:51], s92 offen nt
  s_add_u32 s92, s92, 36864
  buffer_load_dwordx4 v[44:47], v2, s[48:51], s92 offen nt
  s_add_u32 s92, s92, 36864
  buffer_load_dwordx4 v[48:51], v2, s[48:51], s92 offen nt
  s_add_u32 s92, s92, 36864
  buffer_load_dwordx4 v[52:55], v2, s[48:51], s92 offen nt
  s_add_u32 s92, s92, 36864
  buffer_load_dwordx4 v[56:59], v2, s[48:51], s92 offen nt
  buffer_load_dwordx4 v[60:63], v2, s[52:55], s93 offen nt
  s_add_u32 s93, s93, 36864
  buffer_load_dwordx4 v[64:67], v2, s[52:55], s93 offen nt
  s_add_u32 s93, s93, 36864
  buffer_load_dwordx4 v[68:71], v2, s[52:55], s93 offen nt
  s_add_u32 s93, s93, 36864
  buffer_load_dwordx4 v[72:75], v2, s[52:55], s93 offen nt
  s_add_u32 s93, s93, 36864
  buffer_load_dwordx4 v[76:79], v2, s[52:55], s93 offen nt
  s_add_u32 s93, s93, 36864
  buffer_load_dwordx4 v[80:83], v2, s[52:55], s93 offen nt
  s_add_u32 s93, s93, 36864
  buffer_load_dwordx4 v[84:87], v2, s[52:55], s93 offen nt
  s_add_u32 s93, s93, 36864
  buffer_load_dwordx4 v[88:91], v2, s[52:55], s93 offen nt
  s_add_u32 s93, s93, 36864
  buffer_load_dwordx4 v[92:95], v2, s[52:55], s93 offen nt
  s_load_dword s30, s[76:77], 0
  s_barrier
  v_lshlrev_b32 v138, 2, v138
  s_waitcnt vmcnt(24)
  v_lshlrev_b32 v144, 16, v144
  v_lshlrev_b32 v145, 16, v145
  v_add_u32 v139, 0, v138
  ds_bpermute_b32 v96, v139, v144
  ds_bpermute_b32 v97, v139, v145
  v_add_u32 v139, 32, v138
  ds_bpermute_b32 v98, v139, v144
  ds_bpermute_b32 v99, v139, v145
  v_add_u32 v139, 64, v138
  ds_bpermute_b32 v100, v139, v144
  ds_bpermute_b32 v101, v139, v145
  v_add_u32 v139, 96, v138
  ds_bpermute_b32 v102, v139, v144
  ds_bpermute_b32 v103, v139, v145
  v_add_u32 v139, 128, v138
  ds_bpermute_b32 v104, v139, v144
  ds_bpermute_b32 v105, v139, v145
  s_waitcnt vmcnt(23)
  v_lshlrev_b32 v143, 16, v143
  s_nop 0
  v_readlane_b32 s5, v143, 0
  v_readlane_b32 s4, v143, 16
  v_readlane_b32 s7, v143, 1
  v_readlane_b32 s6, v143, 17
  v_readlane_b32 s9, v143, 2
  v_readlane_b32 s8, v143, 18
  v_readlane_b32 s11, v143, 3
  v_readlane_b32 s10, v143, 19
  v_readlane_b32 s13, v143, 4
  v_readlane_b32 s12, v143, 20
  v_readlane_b32 s15, v143, 5
  v_readlane_b32 s14, v143, 21
  v_readlane_b32 s17, v143, 6
  v_readlane_b32 s16, v143, 22
  v_readlane_b32 s19, v143, 7
  v_readlane_b32 s18, v143, 23
  v_readlane_b32 s21, v143, 8
  v_readlane_b32 s20, v143, 24
  s_waitcnt lgkmcnt(0)
  s_add_u32 s30, s30, 1
  v_mov_b32 v136, s30
  v_and_b32 v136, s31, v136
  s_waitcnt vmcnt(22)
  v_lshlrev_b32 v128, 16, v4
  v_and_b32 v129, 0xffff0000, v4
  v_lshlrev_b32 v130, 16, v5
  v_and_b32 v131, 0xffff0000, v5
  v_lshlrev_b32 v132, 16, v6
  v_and_b32 v133, 0xffff0000, v6
  v_lshlrev_b32 v134, 16, v7
  v_and_b32 v135, 0xffff0000, v7
  v_mul_f32 v112, v96, v128
  v_mul_f32 v120, v97, v128
  v_mul_f32 v113, v96, v129
  v_mul_f32 v121, v97, v129
  v_mul_f32 v114, v96, v130
  v_mul_f32 v122, v97, v130
  v_mul_f32 v115, v96, v131
  v_mul_f32 v123, v97, v131
  v_mul_f32 v116, v96, v132
  v_mul_f32 v124, v97, v132
  v_mul_f32 v117, v96, v133
  v_mul_f32 v125, v97, v133
  v_mul_f32 v118, v96, v134
  v_mul_f32 v126, v97, v134
  v_mul_f32 v119, v96, v135
  v_mul_f32 v127, v97, v135
  s_waitcnt vmcnt(21)
  v_lshlrev_b32 v128, 16, v8
  v_and_b32 v129, 0xffff0000, v8
  v_lshlrev_b32 v130, 16, v9
  v_and_b32 v131, 0xffff0000, v9
  v_lshlrev_b32 v132, 16, v10
  v_and_b32 v133, 0xffff0000, v10
  v_lshlrev_b32 v134, 16, v11
  v_and_b32 v135, 0xffff0000, v11
  v_fmac_f32 v112, v98, v128
  v_fmac_f32 v120, v99, v128
  v_fmac_f32 v113, v98, v129
  v_fmac_f32 v121, v99, v129
  v_fmac_f32 v114, v98, v130
  v_fmac_f32 v122, v99, v130
  v_fmac_f32 v115, v98, v131
  v_fmac_f32 v123, v99, v131
  v_fmac_f32 v116, v98, v132
  v_fmac_f32 v124, v99, v132
  v_fmac_f32 v117, v98, v133
  v_fmac_f32 v125, v99, v133
  v_fmac_f32 v118, v98, v134
  v_fmac_f32 v126, v99, v134
  v_fmac_f32 v119, v98, v135
  v_fmac_f32 v127, v99, v135
  s_waitcnt vmcnt(20)
  v_lshlrev_b32 v128, 16, v12
  v_and_b32 v129, 0xffff0000, v12
  v_lshlrev_b32 v130, 16, v13
  v_and_b32 v131, 0xffff0000, v13
  v_lshlrev_b32 v132, 16, v14
  v_and_b32 v133, 0xffff0000, v14
  v_lshlrev_b32 v134, 16, v15
  v_and_b32 v135, 0xffff0000, v15
  v_fmac_f32 v112, v100, v128
  v_fmac_f32 v120, v101, v128
  v_fmac_f32 v113, v100, v129
  v_fmac_f32 v121, v101, v129
  v_fmac_f32 v114, v100, v130
  v_fmac_f32 v122, v101, v130
  v_fmac_f32 v115, v100, v131
  v_fmac_f32 v123, v101, v131
  v_fmac_f32 v116, v100, v132
  v_fmac_f32 v124, v101, v132
  v_fmac_f32 v117, v100, v133
  v_fmac_f32 v125, v101, v133
  v_fmac_f32 v118, v100, v134
  v_fmac_f32 v126, v101, v134
  v_fmac_f32 v119, v100, v135
  v_fmac_f32 v127, v101, v135
  s_waitcnt vmcnt(19)
  v_lshlrev_b32 v128, 16, v16
  v_and_b32 v129, 0xffff0000, v16
  v_lshlrev_b32 v130, 16, v17
  v_and_b32 v131, 0xffff0000, v17
  v_lshlrev_b32 v132, 16, v18
  v_and_b32 v133, 0xffff0000, v18
  v_lshlrev_b32 v134, 16, v19
  v_and_b32 v135, 0xffff0000, v19
  v_fmac_f32 v112, v102, v128
  v_fmac_f32 v120, v103, v128
  v_fmac_f32 v113, v102, v129
  v_fmac_f32 v121, v103, v129
  v_fmac_f32 v114, v102, v130
  v_fmac_f32 v122, v103, v130
  v_fmac_f32 v115, v102, v131
  v_fmac_f32 v123, v103, v131
  v_fmac_f32 v116, v102, v132
  v_fmac_f32 v124, v103, v132
  v_fmac_f32 v117, v102, v133
  v_fmac_f32 v125, v103, v133
  v_fmac_f32 v118, v102, v134
  v_fmac_f32 v126, v103, v134
  v_fmac_f32 v119, v102, v135
  v_fmac_f32 v127, v103, v135
  s_waitcnt vmcnt(18)
  v_lshlrev_b32 v128, 16, v20
  v_and_b32 v129, 0xffff0000, v20
  v_lshlrev_b32 v130, 16, v21
  v_and_b32 v131, 0xffff0000, v21
  v_lshlrev_b32 v132, 16, v22
  v_and_b32 v133, 0xffff0000, v22
  v_lshlrev_b32 v134, 16, v23
  v_and_b32 v135, 0xffff0000, v23
  v_fmac_f32 v112, v104, v128
  v_fmac_f32 v120, v105, v128
  v_fmac_f32 v113, v104, v129
  v_fmac_f32 v121, v105, v129
  v_fmac_f32 v114, v104, v130
  v_fmac_f32 v122, v105, v130
  v_fmac_f32 v115, v104, v131
  v_fmac_f32 v123, v105, v131
  v_fmac_f32 v116, v104, v132
  v_fmac_f32 v124, v105, v132
  v_fmac_f32 v117, v104, v133
  v_fmac_f32 v125, v105, v133
  v_fmac_f32 v118, v104, v134
  v_fmac_f32 v126, v105, v134
  v_fmac_f32 v119, v104, v135
  v_fmac_f32 v127, v105, v135
  s_nop 1
  v_permlane32_swap_b32 v112, v120
  v_permlane32_swap_b32 v113, v121
  v_permlane32_swap_b32 v114, v122
  v_permlane32_swap_b32 v115, v123
  v_permlane32_swap_b32 v116, v124
  v_permlane32_swap_b32 v117, v125
  v_permlane32_swap_b32 v118, v126
  v_permlane32_swap_b32 v119, v127
  s_nop 1
  v_add_f32 v112, v112, v120
  v_add_f32 v113, v113, v121
  v_add_f32 v114, v114, v122
  v_add_f32 v115, v115, v123
  v_add_f32 v116, v116, v124
  v_add_f32 v117, v117, v125
  v_add_f32 v118, v118, v126
  v_add_f32 v119, v119, v127
  s_nop 1
  v_permlane16_swap_b32 v112, v116
  v_permlane16_swap_b32 v113, v117
  v_permlane16_swap_b32 v114, v118
  v_permlane16_swap_b32 v115, v119
  s_nop 1
  v_add_f32 v112, v112, v116
  v_add_f32 v113, v113, v117
  v_add_f32 v114, v114, v118
  v_add_f32 v115, v115, v119
  s_nop 1
  v_add_f32_dpp v112, v112, v112 row_ror:8 row_mask:0xf bank_mask:0xf
  v_add_f32_dpp v113, v113, v113 row_ror:8 row_mask:0xf bank_mask:0xf
  v_add_f32_dpp v114, v114, v114 row_ror:8 row_mask:0xf bank_mask:0xf
  v_add_f32_dpp v115, v115, v115 row_ror:8 row_mask:0xf bank_mask:0xf
  v_lshrrev_b32 v138, 5, v0
  v_lshlrev_b32 v138, 8, v138
  v_and_b32 v139, 7, v0
  v_lshl_add_u32 v138, v139, 5, v138
  v_and_b32 v139, 16, v0
  v_add_u32 v138, v138, v139
  s_lshl_b32 s87, s86, 9
  v_add_u32 v138, s87, v138
  s_mov_b32 exec_lo, 0x00ff00ff
  s_mov_b32 exec_hi, 0x00ff00ff
  ds_write_b128 v138, v[112:115] offset:2048
  s_mov_b64 exec, -1
  s_waitcnt lgkmcnt(0)
  s_mov_b64 exec, 1
  ds_add_rtn_u32 v139, v3, v137 offset:0
  s_waitcnt lgkmcnt(0)
  v_readfirstlane_b32 s99, v139
  s_mov_b64 exec, -1
  s_cmp_lg_u32 s99, 3
  s_cbranch_scc1 L_noq
  s_mov_b64 exec, 0xffffffff
  ds_read_b128 v[4:7], v142 offset:2048
  ds_read_b128 v[8:11], v142 offset:2560
  ds_read_b128 v[12:15], v142 offset:3072
  ds_read_b128 v[16:19], v142 offset:3584
  v_lshrrev_b32 v138, 4, v0
  v_lshlrev_b32 v138, 12, v138
  v_and_b32 v139, 15, v0
  v_lshl_add_u32 v138, v139, 4, v138
  s_lshl_b32 s87, s84, 13
  s_lshr_b32 s88, s85, 2
  s_lshl_b32 s88, s88, 10
  s_add_u32 s87, s87, s88
  s_and_b32 s88, s85, 3
  s_lshl_b32 s88, s88, 8
  s_add_u32 s87, s87, s88
  s_waitcnt lgkmcnt(0)
  v_add_f32 v4, v4, v8
  v_add_f32 v12, v12, v16
  v_add_f32 v5, v5, v9
  v_add_f32 v13, v13, v17
  v_add_f32 v6, v6, v10
  v_add_f32 v14, v14, v18
  v_add_f32 v7, v7, v11
  v_add_f32 v15, v15, v19
  v_add_f32 v4, v4, v12
  v_add_f32 v5, v5, v13
  v_add_f32 v6, v6, v14
  v_add_f32 v7, v7, v15
  v_bfi_b32 v4, s31, v136, v4
  v_bfi_b32 v5, s31, v136, v5
  v_bfi_b32 v6, s31, v136, v6
  v_bfi_b32 v7, s31, v136, v7
  buffer_store_dwordx4 v[4:7], v138, s[60:63], s87 offen sc1
  s_mov_b64 exec, -1
L_noq:
  s_mul_i32 s87, s86, 4608
  v_lshlrev_b32 v138, 5, v0
  v_add_u32 v138, s87, v138
  s_waitcnt vmcnt(17)
  v_lshlrev_b32 v128, 16, v24
  v_and_b32 v129, 0xffff0000, v24
  v_lshlrev_b32 v130, 16, v25
  v_and_b32 v131, 0xffff0000, v25
  v_lshlrev_b32 v132, 16, v26
  v_and_b32 v133, 0xffff0000, v26
  v_lshlrev_b32 v134, 16, v27
  v_and_b32 v135, 0xffff0000, v27
  v_mul_f32 v112, s5, v128
  v_mul_f32 v120, s4, v128
  v_mul_f32 v113, s5, v129
  v_mul_f32 v121, s4, v129
  v_mul_f32 v114, s5, v130
  v_mul_f32 v122, s4, v130
  v_mul_f32 v115, s5, v131
  v_mul_f32 v123, s4, v131
  v_mul_f32 v116, s5, v132
  v_mul_f32 v124, s4, v132
  v_mul_f32 v117, s5, v133
  v_mul_f32 v125, s4, v133
  v_mul_f32 v118, s5, v134
  v_mul_f32 v126, s4, v134
  v_mul_f32 v119, s5, v135
  v_mul_f32 v127, s4, v135
  s_waitcnt vmcnt(16)
  v_lshlrev_b32 v128, 16, v28
  v_and_b32 v129, 0xffff0000, v28
  v_lshlrev_b32 v130, 16, v29
  v_and_b32 v131, 0xffff0000, v29
  v_lshlrev_b32 v132, 16, v30
  v_and_b32 v133, 0xffff0000, v30
  v_lshlrev_b32 v134, 16, v31
  v_and_b32 v135, 0xffff0000, v31
  v_fmac_f32 v112, s7, v128
  v_fmac_f32 v120, s6, v128
  v_fmac_f32 v113, s7, v129
  v_fmac_f32 v121, s6, v129
  v_fmac_f32 v114, s7, v130
  v_fmac_f32 v122, s6, v130
  v_fmac_f32 v115, s7, v131
  v_fmac_f32 v123, s6, v131
  v_fmac_f32 v116, s7, v132
  v_fmac_f32 v124, s6, v132
  v_fmac_f32 v117, s7, v133
  v_fmac_f32 v125, s6, v133
  v_fmac_f32 v118, s7, v134
  v_fmac_f32 v126, s6, v134
  v_fmac_f32 v119, s7, v135
  v_fmac_f32 v127, s6, v135
  s_waitcnt vmcnt(15)
  v_lshlrev_b32 v128, 16, v32
  v_and_b32 v129, 0xffff0000, v32
  v_lshlrev_b32 v130, 16, v33
  v_and_b32 v131, 0xffff0000, v33
  v_lshlrev_b32 v132, 16, v34
  v_and_b32 v133, 0xffff0000, v34
  v_lshlrev_b32 v134, 16, v35
  v_and_b32 v135, 0xffff0000, v35
  v_fmac_f32 v112, s9, v128
  v_fmac_f32 v120, s8, v128
  v_fmac_f32 v113, s9, v129
  v_fmac_f32 v121, s8, v129
  v_fmac_f32 v114, s9, v130
  v_fmac_f32 v122, s8, v130
  v_fmac_f32 v115, s9, v131
  v_fmac_f32 v123, s8, v131
  v_fmac_f32 v116, s9, v132
  v_fmac_f32 v124, s8, v132
  v_fmac_f32 v117, s9, v133
  v_fmac_f32 v125, s8, v133
  v_fmac_f32 v118, s9, v134
  v_fmac_f32 v126, s8, v134
  v_fmac_f32 v119, s9, v135
  v_fmac_f32 v127, s8, v135
  s_waitcnt vmcnt(14)
  v_lshlrev_b32 v128, 16, v36
  v_and_b32 v129, 0xffff0000, v36
  v_lshlrev_b32 v130, 16, v37
  v_and_b32 v131, 0xffff0000, v37
  v_lshlrev_b32 v132, 16, v38
  v_and_b32 v133, 0xffff0000, v38
  v_lshlrev_b32 v134, 16, v39
  v_and_b32 v135, 0xffff0000, v39
  v_fmac_f32 v112, s11, v128
  v_fmac_f32 v120, s10, v128
  v_fmac_f32 v113, s11, v129
  v_fmac_f32 v121, s10, v129
  v_fmac_f32 v114, s11, v130
  v_fmac_f32 v122, s10, v130
  v_fmac_f32 v115, s11, v131
  v_fmac_f32 v123, s10, v131
  v_fmac_f32 v116, s11, v132
  v_fmac_f32 v124, s10, v132
  v_fmac_f32 v117, s11, v133
  v_fmac_f32 v125, s10, v133
  v_fmac_f32 v118, s11, v134
  v_fmac_f32 v126, s10, v134
  v_fmac_f32 v119, s11, v135
  v_fmac_f32 v127, s10, v135
  s_waitcnt vmcnt(13)
  v_lshlrev_b32 v128, 16, v40
  v_and_b32 v129, 0xffff0000, v40
  v_lshlrev_b32 v130, 16, v41
  v_and_b32 v131, 0xffff0000, v41
  v_lshlrev_b32 v132, 16, v42
  v_and_b32 v133, 0xffff0000, v42
  v_lshlrev_b32 v134, 16, v43
  v_and_b32 v135, 0xffff0000, v43
  v_fmac_f32 v112, s13, v128
  v_fmac_f32 v120, s12, v128
  v_fmac_f32 v113, s13, v129
  v_fmac_f32 v121, s12, v129
  v_fmac_f32 v114, s13, v130
  v_fmac_f32 v122, s12, v130
  v_fmac_f32 v115, s13, v131
  v_fmac_f32 v123, s12, v131
  v_fmac_f32 v116, s13, v132
  v_fmac_f32 v124, s12, v132
  v_fmac_f32 v117, s13, v133
  v_fmac_f32 v125, s12, v133
  v_fmac_f32 v118, s13, v134
  v_fmac_f32 v126, s12, v134
  v_fmac_f32 v119, s13, v135
  v_fmac_f32 v127, s12, v135
  s_waitcnt vmcnt(12)
  v_lshlrev_b32 v128, 16, v44
  v_and_b32 v129, 0xffff0000, v44
  v_lshlrev_b32 v130, 16, v45
  v_and_b32 v131, 0xffff0000, v45
  v_lshlrev_b32 v132, 16, v46
  v_and_b32 v133, 0xffff0000, v46
  v_lshlrev_b32 v134, 16, v47
  v_and_b32 v135, 0xffff0000, v47
  v_fmac_f32 v112, s15, v128
  v_fmac_f32 v120, s14, v128
  v_fmac_f32 v113, s15, v129
  v_fmac_f32 v121, s14, v129
  v_fmac_f32 v114, s15, v130
  v_fmac_f32 v122, s14, v130
  v_fmac_f32 v115, s15, v131
  v_fmac_f32 v123, s14, v131
  v_fmac_f32 v116, s15, v132
  v_fmac_f32 v124, s14, v132
  v_fmac_f32 v117, s15, v133
  v_fmac_f32 v125, s14, v133
  v_fmac_f32 v118, s15, v134
  v_fmac_f32 v126, s14, v134
  v_fmac_f32 v119, s15, v135
  v_fmac_f32 v127, s14, v135
  s_waitcnt vmcnt(11)
  v_lshlrev_b32 v128, 16, v48
  v_and_b32 v129, 0xffff0000, v48
  v_lshlrev_b32 v130, 16, v49
  v_and_b32 v131, 0xffff0000, v49
  v_lshlrev_b32 v132, 16, v50
  v_and_b32 v133, 0xffff0000, v50
  v_lshlrev_b32 v134, 16, v51
  v_and_b32 v135, 0xffff0000, v51
  v_fmac_f32 v112, s17, v128
  v_fmac_f32 v120, s16, v128
  v_fmac_f32 v113, s17, v129
  v_fmac_f32 v121, s16, v129
  v_fmac_f32 v114, s17, v130
  v_fmac_f32 v122, s16, v130
  v_fmac_f32 v115, s17, v131
  v_fmac_f32 v123, s16, v131
  v_fmac_f32 v116, s17, v132
  v_fmac_f32 v124, s16, v132
  v_fmac_f32 v117, s17, v133
  v_fmac_f32 v125, s16, v133
  v_fmac_f32 v118, s17, v134
  v_fmac_f32 v126, s16, v134
  v_fmac_f32 v119, s17, v135
  v_fmac_f32 v127, s16, v135
  s_waitcnt vmcnt(10)
  v_lshlrev_b32 v128, 16, v52
  v_and_b32 v129, 0xffff0000, v52
  v_lshlrev_b32 v130, 16, v53
  v_and_b32 v131, 0xffff0000, v53
  v_lshlrev_b32 v132, 16, v54
  v_and_b32 v133, 0xffff0000, v54
  v_lshlrev_b32 v134, 16, v55
  v_and_b32 v135, 0xffff0000, v55
  v_fmac_f32 v112, s19, v128
  v_fmac_f32 v120, s18, v128
  v_fmac_f32 v113, s19, v129
  v_fmac_f32 v121, s18, v129
  v_fmac_f32 v114, s19, v130
  v_fmac_f32 v122, s18, v130
  v_fmac_f32 v115, s19, v131
  v_fmac_f32 v123, s18, v131
  v_fmac_f32 v116, s19, v132
  v_fmac_f32 v124, s18, v132
  v_fmac_f32 v117, s19, v133
  v_fmac_f32 v125, s18, v133
  v_fmac_f32 v118, s19, v134
  v_fmac_f32 v126, s18, v134
  v_fmac_f32 v119, s19, v135
  v_fmac_f32 v127, s18, v135
  s_waitcnt vmcnt(9)
  v_lshlrev_b32 v128, 16, v56
  v_and_b32 v129, 0xffff0000, v56
  v_lshlrev_b32 v130, 16, v57
  v_and_b32 v131, 0xffff0000, v57
  v_lshlrev_b32 v132, 16, v58
  v_and_b32 v133, 0xffff0000, v58
  v_lshlrev_b32 v134, 16, v59
  v_and_b32 v135, 0xffff0000, v59
  v_fmac_f32 v112, s21, v128
  v_fmac_f32 v120, s20, v128
  v_fmac_f32 v113, s21, v129
  v_fmac_f32 v121, s20, v129
  v_fmac_f32 v114, s21, v130
  v_fmac_f32 v122, s20, v130
  v_fmac_f32 v115, s21, v131
  v_fmac_f32 v123, s20, v131
  v_fmac_f32 v116, s21, v132
  v_fmac_f32 v124, s20, v132
  v_fmac_f32 v117, s21, v133
  v_fmac_f32 v125, s20, v133
  v_fmac_f32 v118, s21, v134
  v_fmac_f32 v126, s20, v134
  v_fmac_f32 v119, s21, v135
  v_fmac_f32 v127, s20, v135
  s_mov_b32 exec_lo, -1
  s_mov_b32 exec_hi, 15
  ds_write_b128 v138, v[112:115] offset:4096
  ds_write_b128 v138, v[116:119] offset:4112
  ds_write_b128 v138, v[120:123] offset:5248
  ds_write_b128 v138, v[124:127] offset:5264
  s_mov_b64 exec, -1
  s_nop 1
  s_waitcnt vmcnt(8)
  v_lshlrev_b32 v128, 16, v60
  v_and_b32 v129, 0xffff0000, v60
  v_lshlrev_b32 v130, 16, v61
  v_and_b32 v131, 0xffff0000, v61
  v_lshlrev_b32 v132, 16, v62
  v_and_b32 v133, 0xffff0000, v62
  v_lshlrev_b32 v134, 16, v63
  v_and_b32 v135, 0xffff0000, v63
  v_mul_f32 v112, s5, v128
  v_mul_f32 v120, s4, v128
  v_mul_f32 v113, s5, v129
  v_mul_f32 v121, s4, v129
  v_mul_f32 v114, s5, v130
  v_mul_f32 v122, s4, v130
  v_mul_f32 v115, s5, v131
  v_mul_f32 v123, s4, v131
  v_mul_f32 v116, s5, v132
  v_mul_f32 v124, s4, v132
  v_mul_f32 v117, s5, v133
  v_mul_f32 v125, s4, v133
  v_mul_f32 v118, s5, v134
  v_mul_f32 v126, s4, v134
  v_mul_f32 v119, s5, v135
  v_mul_f32 v127, s4, v135
  s_waitcnt vmcnt(7)
  v_lshlrev_b32 v128, 16, v64
  v_and_b32 v129, 0xffff0000, v64
  v_lshlrev_b32 v130, 16, v65
  v_and_b32 v131, 0xffff0000, v65
  v_lshlrev_b32 v132, 16, v66
  v_and_b32 v133, 0xffff0000, v66
  v_lshlrev_b32 v134, 16, v67
  v_and_b32 v135, 0xffff0000, v67
  v_fmac_f32 v112, s7, v128
  v_fmac_f32 v120, s6, v128
  v_fmac_f32 v113, s7, v129
  v_fmac_f32 v121, s6, v129
  v_fmac_f32 v114, s7, v130
  v_fmac_f32 v122, s6, v130
  v_fmac_f32 v115, s7, v131
  v_fmac_f32 v123, s6, v131
  v_fmac_f32 v116, s7, v132
  v_fmac_f32 v124, s6, v132
  v_fmac_f32 v117, s7, v133
  v_fmac_f32 v125, s6, v133
  v_fmac_f32 v118, s7, v134
  v_fmac_f32 v126, s6, v134
  v_fmac_f32 v119, s7, v135
  v_fmac_f32 v127, s6, v135
  s_waitcnt vmcnt(6)
  v_lshlrev_b32 v128, 16, v68
  v_and_b32 v129, 0xffff0000, v68
  v_lshlrev_b32 v130, 16, v69
  v_and_b32 v131, 0xffff0000, v69
  v_lshlrev_b32 v132, 16, v70
  v_and_b32 v133, 0xffff0000, v70
  v_lshlrev_b32 v134, 16, v71
  v_and_b32 v135, 0xffff0000, v71
  v_fmac_f32 v112, s9, v128
  v_fmac_f32 v120, s8, v128
  v_fmac_f32 v113, s9, v129
  v_fmac_f32 v121, s8, v129
  v_fmac_f32 v114, s9, v130
  v_fmac_f32 v122, s8, v130
  v_fmac_f32 v115, s9, v131
  v_fmac_f32 v123, s8, v131
  v_fmac_f32 v116, s9, v132
  v_fmac_f32 v124, s8, v132
  v_fmac_f32 v117, s9, v133
  v_fmac_f32 v125, s8, v133
  v_fmac_f32 v118, s9, v134
  v_fmac_f32 v126, s8, v134
  v_fmac_f32 v119, s9, v135
  v_fmac_f32 v127, s8, v135
  s_waitcnt vmcnt(5)
  v_lshlrev_b32 v128, 16, v72
  v_and_b32 v129, 0xffff0000, v72
  v_lshlrev_b32 v130, 16, v73
  v_and_b32 v131, 0xffff0000, v73
  v_lshlrev_b32 v132, 16, v74
  v_and_b32 v133, 0xffff0000, v74
  v_lshlrev_b32 v134, 16, v75
  v_and_b32 v135, 0xffff0000, v75
  v_fmac_f32 v112, s11, v128
  v_fmac_f32 v120, s10, v128
  v_fmac_f32 v113, s11, v129
  v_fmac_f32 v121, s10, v129
  v_fmac_f32 v114, s11, v130
  v_fmac_f32 v122, s10, v130
  v_fmac_f32 v115, s11, v131
  v_fmac_f32 v123, s10, v131
  v_fmac_f32 v116, s11, v132
  v_fmac_f32 v124, s10, v132
  v_fmac_f32 v117, s11, v133
  v_fmac_f32 v125, s10, v133
  v_fmac_f32 v118, s11, v134
  v_fmac_f32 v126, s10, v134
  v_fmac_f32 v119, s11, v135
  v_fmac_f32 v127, s10, v135
  s_waitcnt vmcnt(4)
  v_lshlrev_b32 v128, 16, v76
  v_and_b32 v129, 0xffff0000, v76
  v_lshlrev_b32 v130, 16, v77
  v_and_b32 v131, 0xffff0000, v77
  v_lshlrev_b32 v132, 16, v78
  v_and_b32 v133, 0xffff0000, v78
  v_lshlrev_b32 v134, 16, v79
  v_and_b32 v135, 0xffff0000, v79
  v_fmac_f32 v112, s13, v128
  v_fmac_f32 v120, s12, v128
  v_fmac_f32 v113, s13, v129
  v_fmac_f32 v121, s12, v129
  v_fmac_f32 v114, s13, v130
  v_fmac_f32 v122, s12, v130
  v_fmac_f32 v115, s13, v131
  v_fmac_f32 v123, s12, v131
  v_fmac_f32 v116, s13, v132
  v_fmac_f32 v124, s12, v132
  v_fmac_f32 v117, s13, v133
  v_fmac_f32 v125, s12, v133
  v_fmac_f32 v118, s13, v134
  v_fmac_f32 v126, s12, v134
  v_fmac_f32 v119, s13, v135
  v_fmac_f32 v127, s12, v135
  s_waitcnt vmcnt(3)
  v_lshlrev_b32 v128, 16, v80
  v_and_b32 v129, 0xffff0000, v80
  v_lshlrev_b32 v130, 16, v81
  v_and_b32 v131, 0xffff0000, v81
  v_lshlrev_b32 v132, 16, v82
  v_and_b32 v133, 0xffff0000, v82
  v_lshlrev_b32 v134, 16, v83
  v_and_b32 v135, 0xffff0000, v83
  v_fmac_f32 v112, s15, v128
  v_fmac_f32 v120, s14, v128
  v_fmac_f32 v113, s15, v129
  v_fmac_f32 v121, s14, v129
  v_fmac_f32 v114, s15, v130
  v_fmac_f32 v122, s14, v130
  v_fmac_f32 v115, s15, v131
  v_fmac_f32 v123, s14, v131
  v_fmac_f32 v116, s15, v132
  v_fmac_f32 v124, s14, v132
  v_fmac_f32 v117, s15, v133
  v_fmac_f32 v125, s14, v133
  v_fmac_f32 v118, s15, v134
  v_fmac_f32 v126, s14, v134
  v_fmac_f32 v119, s15, v135
  v_fmac_f32 v127, s14, v135
  s_waitcnt vmcnt(2)
  v_lshlrev_b32 v128, 16, v84
  v_and_b32 v129, 0xffff0000, v84
  v_lshlrev_b32 v130, 16, v85
  v_and_b32 v131, 0xffff0000, v85
  v_lshlrev_b32 v132, 16, v86
  v_and_b32 v133, 0xffff0000, v86
  v_lshlrev_b32 v134, 16, v87
  v_and_b32 v135, 0xffff0000, v87
  v_fmac_f32 v112, s17, v128
  v_fmac_f32 v120, s16, v128
  v_fmac_f32 v113, s17, v129
  v_fmac_f32 v121, s16, v129
  v_fmac_f32 v114, s17, v130
  v_fmac_f32 v122, s16, v130
  v_fmac_f32 v115, s17, v131
  v_fmac_f32 v123, s16, v131
  v_fmac_f32 v116, s17, v132
  v_fmac_f32 v124, s16, v132
  v_fmac_f32 v117, s17, v133
  v_fmac_f32 v125, s16, v133
  v_fmac_f32 v118, s17, v134
  v_fmac_f32 v126, s16, v134
  v_fmac_f32 v119, s17, v135
  v_fmac_f32 v127, s16, v135
  s_waitcnt vmcnt(1)
  v_lshlrev_b32 v128, 16, v88
  v_and_b32 v129, 0xffff0000, v88
  v_lshlrev_b32 v130, 16, v89
  v_and_b32 v131, 0xffff0000, v89
  v_lshlrev_b32 v132, 16, v90
  v_and_b32 v133, 0xffff0000, v90
  v_lshlrev_b32 v134, 16, v91
  v_and_b32 v135, 0xffff0000, v91
  v_fmac_f32 v112, s19, v128
  v_fmac_f32 v120, s18, v128
  v_fmac_f32 v113, s19, v129
  v_fmac_f32 v121, s18, v129
  v_fmac_f32 v114, s19, v130
  v_fmac_f32 v122, s18, v130
  v_fmac_f32 v115, s19, v131
  v_fmac_f32 v123, s18, v131
  v_fmac_f32 v116, s19, v132
  v_fmac_f32 v124, s18, v132
  v_fmac_f32 v117, s19, v133
  v_fmac_f32 v125, s18, v133
  v_fmac_f32 v118, s19, v134
  v_fmac_f32 v126, s18, v134
  v_fmac_f32 v119, s19, v135
  v_fmac_f32 v127, s18, v135
  s_waitcnt vmcnt(0)
  v_lshlrev_b32 v128, 16, v92
  v_and_b32 v129, 0xffff0000, v92
  v_lshlrev_b32 v130, 16, v93
  v_and_b32 v131, 0xffff0000, v93
  v_lshlrev_b32 v132, 16, v94
  v_and_b32 v133, 0xffff0000, v94
  v_lshlrev_b32 v134, 16, v95
  v_and_b32 v135, 0xffff0000, v95
  v_fmac_f32 v112, s21, v128
  v_fmac_f32 v120, s20, v128
  v_fmac_f32 v113, s21, v129
  v_fmac_f32 v121, s20, v129
  v_fmac_f32 v114, s21, v130
  v_fmac_f32 v122, s20, v130
  v_fmac_f32 v115, s21, v131
  v_fmac_f32 v123, s20, v131
  v_fmac_f32 v116, s21, v132
  v_fmac_f32 v124, s20, v132
  v_fmac_f32 v117, s21, v133
  v_fmac_f32 v125, s20, v133
  v_fmac_f32 v118, s21, v134
  v_fmac_f32 v126, s20, v134
  v_fmac_f32 v119, s21, v135
  v_fmac_f32 v127, s20, v135
  s_mov_b32 exec_lo, -1
  s_mov_b32 exec_hi, 15
  ds_write_b128 v138, v[112:115] offset:6400
  ds_write_b128 v138, v[116:119] offset:6416
  ds_write_b128 v138, v[120:123] offset:7552
  ds_write_b128 v138, v[124:127] offset:7568
  s_mov_b64 exec, -1
  s_nop 1
  s_waitcnt lgkmcnt(0)
  s_mov_b64 exec, 1
  ds_add_rtn_u32 v139, v3, v137 offset:4
  s_waitcnt lgkmcnt(0)
  v_readfirstlane_b32 s99, v139
  s_mov_b64 exec, -1
  s_cmp_lg_u32 s99, 3
  s_cbranch_scc1 L_noh
  s_mul_i32 s87, s2, 5120
  s_add_u32 s87, s87, 524288
  s_add_u32 s88, s87, 4096
  v_add_u32 v138, 0, v0
  v_mul_u32_u24 v139, 3277, v138
  v_lshrrev_b32 v139, 16, v139
  v_mul_u32_u24 v140, 20, v139
  v_sub_u32 v138, v138, v140
  v_mul_u32_u24 v140, 52, v138
  v_lshrrev_b32 v140, 8, v140
  v_mul_u32_u24 v141, 5, v140
  v_sub_u32 v138, v138, v141
  v_lshlrev_b32 v138, 4, v138
  v_mul_u32_u24 v140, 1152, v140
  v_mul_u32_u24 v139, 72, v139
  v_add3_u32 v138, v138, v139, v140
  ds_read_b64 v[4:5], v138 offset:4096
  ds_read_b64 v[6:7], v138 offset:4104
  ds_read_b64 v[8:9], v138 offset:8704
  ds_read_b64 v[10:11], v138 offset:8712
  ds_read_b64 v[12:13], v138 offset:13312
  ds_read_b64 v[14:15], v138 offset:13320
  ds_read_b64 v[16:17], v138 offset:17920
  ds_read_b64 v[18:19], v138 offset:17928
  s_waitcnt lgkmcnt(0)
  v_add_f32 v4, v4, v8
  v_add_f32 v12, v12, v16
  v_add_f32 v5, v5, v9
  v_add_f32 v13, v13, v17
  v_add_f32 v6, v6, v10
  v_add_f32 v14, v14, v18
  v_add_f32 v7, v7, v11
  v_add_f32 v15, v15, v19
  v_add_f32 v4, v4, v12
  v_add_f32 v5, v5, v13
  v_add_f32 v6, v6, v14
  v_add_f32 v7, v7, v15
  v_bfi_b32 v4, s31, v136, v4
  v_bfi_b32 v5, s31, v136, v5
  v_bfi_b32 v6, s31, v136, v6
  v_bfi_b32 v7, s31, v136, v7
  buffer_store_dwordx4 v[4:7], v142, s[60:63], s87 offen offset:0 sc1
  v_add_u32 v138, 64, v0
  v_mul_u32_u24 v139, 3277, v138
  v_lshrrev_b32 v139, 16, v139
  v_mul_u32_u24 v140, 20, v139
  v_sub_u32 v138, v138, v140
  v_mul_u32_u24 v140, 52, v138
  v_lshrrev_b32 v140, 8, v140
  v_mul_u32_u24 v141, 5, v140
  v_sub_u32 v138, v138, v141
  v_lshlrev_b32 v138, 4, v138
  v_mul_u32_u24 v140, 1152, v140
  v_mul_u32_u24 v139, 72, v139
  v_add3_u32 v138, v138, v139, v140
  ds_read_b64 v[20:21], v138 offset:4096
  ds_read_b64 v[22:23], v138 offset:4104
  ds_read_b64 v[24:25], v138 offset:8704
  ds_read_b64 v[26:27], v138 offset:8712
  ds_read_b64 v[28:29], v138 offset:13312
  ds_read_b64 v[30:31], v138 offset:13320
  ds_read_b64 v[32:33], v138 offset:17920
  ds_read_b64 v[34:35], v138 offset:17928
  s_waitcnt lgkmcnt(0)
  v_add_f32 v20, v20, v24
  v_add_f32 v28, v28, v32
  v_add_f32 v21, v21, v25
  v_add_f32 v29, v29, v33
  v_add_f32 v22, v22, v26
  v_add_f32 v30, v30, v34
  v_add_f32 v23, v23, v27
  v_add_f32 v31, v31, v35
  v_add_f32 v20, v20, v28
  v_add_f32 v21, v21, v29
  v_add_f32 v22, v22, v30
  v_add_f32 v23, v23, v31
  v_bfi_b32 v20, s31, v136, v20
  v_bfi_b32 v21, s31, v136, v21
  v_bfi_b32 v22, s31, v136, v22
  v_bfi_b32 v23, s31, v136, v23
  buffer_store_dwordx4 v[20:23], v142, s[60:63], s87 offen offset:1024 sc1
  v_add_u32 v138, 128, v0
  v_mul_u32_u24 v139, 3277, v138
  v_lshrrev_b32 v139, 16, v139
  v_mul_u32_u24 v140, 20, v139
  v_sub_u32 v138, v138, v140
  v_mul_u32_u24 v140, 52, v138
  v_lshrrev_b32 v140, 8, v140
  v_mul_u32_u24 v141, 5, v140
  v_sub_u32 v138, v138, v141
  v_lshlrev_b32 v138, 4, v138
  v_mul_u32_u24 v140, 1152, v140
  v_mul_u32_u24 v139, 72, v139
  v_add3_u32 v138, v138, v139, v140
  ds_read_b64 v[36:37], v138 offset:4096
  ds_read_b64 v[38:39], v138 offset:4104
  ds_read_b64 v[40:41], v138 offset:8704
  ds_read_b64 v[42:43], v138 offset:8712
  ds_read_b64 v[44:45], v138 offset:13312
  ds_read_b64 v[46:47], v138 offset:13320
  ds_read_b64 v[48:49], v138 offset:17920
  ds_read_b64 v[50:51], v138 offset:17928
  s_waitcnt lgkmcnt(0)
  v_add_f32 v36, v36, v40
  v_add_f32 v44, v44, v48
  v_add_f32 v37, v37, v41
  v_add_f32 v45, v45, v49
  v_add_f32 v38, v38, v42
  v_add_f32 v46, v46, v50
  v_add_f32 v39, v39, v43
  v_add_f32 v47, v47, v51
  v_add_f32 v36, v36, v44
  v_add_f32 v37, v37, v45
  v_add_f32 v38, v38, v46
  v_add_f32 v39, v39, v47
  v_bfi_b32 v36, s31, v136, v36
  v_bfi_b32 v37, s31, v136, v37
  v_bfi_b32 v38, s31, v136, v38
  v_bfi_b32 v39, s31, v136, v39
  buffer_store_dwordx4 v[36:39], v142, s[60:63], s87 offen offset:2048 sc1
  v_add_u32 v138, 192, v0
  v_mul_u32_u24 v139, 3277, v138
  v_lshrrev_b32 v139, 16, v139
  v_mul_u32_u24 v140, 20, v139
  v_sub_u32 v138, v138, v140
  v_mul_u32_u24 v140, 52, v138
  v_lshrrev_b32 v140, 8, v140
  v_mul_u32_u24 v141, 5, v140
  v_sub_u32 v138, v138, v141
  v_lshlrev_b32 v138, 4, v138
  v_mul_u32_u24 v140, 1152, v140
  v_mul_u32_u24 v139, 72, v139
  v_add3_u32 v138, v138, v139, v140
  ds_read_b64 v[52:53], v138 offset:4096
  ds_read_b64 v[54:55], v138 offset:4104
  ds_read_b64 v[56:57], v138 offset:8704
  ds_read_b64 v[58:59], v138 offset:8712
  ds_read_b64 v[60:61], v138 offset:13312
  ds_read_b64 v[62:63], v138 offset:13320
  ds_read_b64 v[64:65], v138 offset:17920
  ds_read_b64 v[66:67], v138 offset:17928
  s_waitcnt lgkmcnt(0)
  v_add_f32 v52, v52, v56
  v_add_f32 v60, v60, v64
  v_add_f32 v53, v53, v57
  v_add_f32 v61, v61, v65
  v_add_f32 v54, v54, v58
  v_add_f32 v62, v62, v66
  v_add_f32 v55, v55, v59
  v_add_f32 v63, v63, v67
  v_add_f32 v52, v52, v60
  v_add_f32 v53, v53, v61
  v_add_f32 v54, v54, v62
  v_add_f32 v55, v55, v63
  v_bfi_b32 v52, s31, v136, v52
  v_bfi_b32 v53, s31, v136, v53
  v_bfi_b32 v54, s31, v136, v54
  v_bfi_b32 v55, s31, v136, v55
  buffer_store_dwordx4 v[52:55], v142, s[60:63], s87 offen offset:3072 sc1
  v_add_u32 v138, 256, v0
  v_mul_u32_u24 v139, 3277, v138
  v_lshrrev_b32 v139, 16, v139
  v_mul_u32_u24 v140, 20, v139
  v_sub_u32 v138, v138, v140
  v_mul_u32_u24 v140, 52, v138
  v_lshrrev_b32 v140, 8, v140
  v_mul_u32_u24 v141, 5, v140
  v_sub_u32 v138, v138, v141
  v_lshlrev_b32 v138, 4, v138
  v_mul_u32_u24 v140, 1152, v140
  v_mul_u32_u24 v139, 72, v139
  v_add3_u32 v138, v138, v139, v140
  ds_read_b64 v[68:69], v138 offset:4096
  ds_read_b64 v[70:71], v138 offset:4104
  ds_read_b64 v[72:73], v138 offset:8704
  ds_read_b64 v[74:75], v138 offset:8712
  ds_read_b64 v[76:77], v138 offset:13312
  ds_read_b64 v[78:79], v138 offset:13320
  ds_read_b64 v[80:81], v138 offset:17920
  ds_read_b64 v[82:83], v138 offset:17928
  s_waitcnt lgkmcnt(0)
  v_add_f32 v68, v68, v72
  v_add_f32 v76, v76, v80
  v_add_f32 v69, v69, v73
  v_add_f32 v77, v77, v81
  v_add_f32 v70, v70, v74
  v_add_f32 v78, v78, v82
  v_add_f32 v71, v71, v75
  v_add_f32 v79, v79, v83
  v_add_f32 v68, v68, v76
  v_add_f32 v69, v69, v77
  v_add_f32 v70, v70, v78
  v_add_f32 v71, v71, v79
  v_bfi_b32 v68, s31, v136, v68
  v_bfi_b32 v69, s31, v136, v69
  v_bfi_b32 v70, s31, v136, v70
  v_bfi_b32 v71, s31, v136, v71
  buffer_store_dwordx4 v[68:71], v142, s[60:63], s88 offen sc1
L_noh:
  v_mov_b32 v146, 1
  s_mov_b32 s17, 0
  s_cmp_eq_u32 s86, 1
  s_cbranch_scc1 L_aux1
  s_cmp_lg_u32 s86, 0
  s_cbranch_scc1 L_aux_final
  s_lshl_b32 s87, s84, 1
  s_lshr_b32 s88, s85, 3
  s_add_u32 s87, s87, s88
  s_lshl_b32 s87, s87, 12
  s_sleep 32
  s_mov_b32 s97, 0
P_8:
  buffer_load_dwordx4 v[96:99], v142, s[60:63], s87 offen offset:0 sc1
  buffer_load_dwordx4 v[100:103], v142, s[60:63], s87 offen offset:1024 sc1
  buffer_load_dwordx4 v[104:107], v142, s[60:63], s87 offen offset:2048 sc1
  buffer_load_dwordx4 v[108:111], v142, s[60:63], s87 offen offset:3072 sc1
  s_waitcnt vmcnt(0)
  v_xor_b32 v140, v136, v96
  v_xor_b32 v141, v136, v97
  v_xor_b32 v139, v136, v98
  v_or3_b32 v140, v140, v141, v139
  v_xor_b32 v141, v136, v99
  v_xor_b32 v139, v136, v100
  v_or3_b32 v140, v140, v141, v139
  v_xor_b32 v141, v136, v101
  v_xor_b32 v139, v136, v102
  v_or3_b32 v140, v140, v141, v139
  v_xor_b32 v141, v136, v103
  v_xor_b32 v139, v136, v104
  v_or3_b32 v140, v140, v141, v139
  v_xor_b32 v141, v136, v105
  v_xor_b32 v139, v136, v106
  v_or3_b32 v140, v140, v141, v139
  v_xor_b32 v141, v136, v107
  v_xor_b32 v139, v136, v108
  v_or3_b32 v140, v140, v141, v139
  v_xor_b32 v141, v136, v109
  v_xor_b32 v139, v136, v110
  v_or3_b32 v140, v140, v141, v139
  v_xor_b32 v141, v136, v111
  v_or_b32 v140, v140, v141
  v_and_b32 v140, s31, v140
  v_cmp_ne_u32 vcc, 0, v140
  s_cmp_eq_u64 vcc, 0
  s_cbranch_scc1 PD_9
  s_add_u32 s97, s97, 1
  s_cmp_lt_u32 s97, 65536
  s_cbranch_scc1 P_8
PD_9:
  v_add_f32 v96, v96, v100
  v_add_f32 v104, v104, v108
  v_add_f32 v97, v97, v101
  v_add_f32 v105, v105, v109
  v_add_f32 v98, v98, v102
  v_add_f32 v106, v106, v110
  v_add_f32 v99, v99, v103
  v_add_f32 v107, v107, v111
  v_add_f32 v96, v96, v104
  v_add_f32 v97, v97, v105
  v_add_f32 v98, v98, v106
  v_add_f32 v99, v99, v107
  v_cvt_pk_bf16_f32 v140, v96, v97
  v_cvt_pk_bf16_f32 v141, v98, v99
  v_lshlrev_b32 v139, 3, v0
  ds_write_b64 v139, v[140:141] offset:512
  s_waitcnt lgkmcnt(0)
  s_mov_b64 exec, 1
  ds_add_u32 v3, v137 offset:8
  s_mov_b64 exec, -1
  s_branch L_aux_final
L_aux1:
  v_lshlrev_b32 v140, 5, v0
  v_mov_b32 v141, 2147483648
  v_cmp_gt_u32 vcc, 36, v0
  s_nop 1
  v_cndmask_b32 v140, v141, v140, vcc
  s_movk_i32 s88, 1152
  buffer_load_dwordx4 v[84:87], v140, s[68:71], 0 offen
  buffer_load_dwordx4 v[88:91], v140, s[68:71], 0 offen offset:16
  buffer_load_dwordx4 v[92:95], v140, s[68:71], s88 offen
  buffer_load_dwordx4 v[96:99], v140, s[68:71], s88 offen offset:16
  buffer_load_dwordx4 v[100:103], v140, s[72:75], 0 offen
  buffer_load_dwordx4 v[104:107], v140, s[72:75], 0 offen offset:16
  s_mul_i32 s87, s84, 81920
  s_mul_i32 s88, s85, 320
  s_add_u32 s87, s87, s88
  s_add_u32 s87, s87, 524288
  v_and_b32 v138, 15, v0
  v_mul_u32_u24 v138, 5120, v138
  v_and_b32 v139, 48, v0
  v_add_u32 v138, v138, v139
  s_waitcnt vmcnt(0)
  v_mov_b32 v64, 0
  v_mov_b32 v65, 0
  v_lshlrev_b32 v128, 16, v100
  v_and_b32 v129, 0xffff0000, v100
  v_lshlrev_b32 v130, 16, v101
  v_and_b32 v131, 0xffff0000, v101
  v_lshlrev_b32 v132, 16, v102
  v_and_b32 v133, 0xffff0000, v102
  v_lshlrev_b32 v134, 16, v103
  v_and_b32 v135, 0xffff0000, v103
  v_lshlrev_b32 v112, 16, v84
  v_and_b32 v113, 0xffff0000, v84
  v_lshlrev_b32 v114, 16, v85
  v_and_b32 v115, 0xffff0000, v85
  v_lshlrev_b32 v116, 16, v86
  v_and_b32 v117, 0xffff0000, v86
  v_lshlrev_b32 v118, 16, v87
  v_and_b32 v119, 0xffff0000, v87
  v_lshlrev_b32 v120, 16, v92
  v_and_b32 v121, 0xffff0000, v92
  v_lshlrev_b32 v122, 16, v93
  v_and_b32 v123, 0xffff0000, v93
  v_lshlrev_b32 v124, 16, v94
  v_and_b32 v125, 0xffff0000, v94
  v_lshlrev_b32 v126, 16, v95
  v_and_b32 v127, 0xffff0000, v95
  v_fmac_f32 v64, v128, v112
  v_fmac_f32 v65, v128, v120
  v_fmac_f32 v64, v129, v113
  v_fmac_f32 v65, v129, v121
  v_fmac_f32 v64, v130, v114
  v_fmac_f32 v65, v130, v122
  v_fmac_f32 v64, v131, v115
  v_fmac_f32 v65, v131, v123
  v_fmac_f32 v64, v132, v116
  v_fmac_f32 v65, v132, v124
  v_fmac_f32 v64, v133, v117
  v_fmac_f32 v65, v133, v125
  v_fmac_f32 v64, v134, v118
  v_fmac_f32 v65, v134, v126
  v_fmac_f32 v64, v135, v119
  v_fmac_f32 v65, v135, v127
  v_lshlrev_b32 v128, 16, v104
  v_and_b32 v129, 0xffff0000, v104
  v_lshlrev_b32 v130, 16, v105
  v_and_b32 v131, 0xffff0000, v105
  v_lshlrev_b32 v132, 16, v106
  v_and_b32 v133, 0xffff0000, v106
  v_lshlrev_b32 v134, 16, v107
  v_and_b32 v135, 0xffff0000, v107
  v_lshlrev_b32 v112, 16, v88
  v_and_b32 v113, 0xffff0000, v88
  v_lshlrev_b32 v114, 16, v89
  v_and_b32 v115, 0xffff0000, v89
  v_lshlrev_b32 v116, 16, v90
  v_and_b32 v117, 0xffff0000, v90
  v_lshlrev_b32 v118, 16, v91
  v_and_b32 v119, 0xffff0000, v91
  v_lshlrev_b32 v120, 16, v96
  v_and_b32 v121, 0xffff0000, v96
  v_lshlrev_b32 v122, 16, v97
  v_and_b32 v123, 0xffff0000, v97
  v_lshlrev_b32 v124, 16, v98
  v_and_b32 v125, 0xffff0000, v98
  v_lshlrev_b32 v126, 16, v99
  v_and_b32 v127, 0xffff0000, v99
  v_fmac_f32 v64, v128, v112
  v_fmac_f32 v65, v128, v120
  v_fmac_f32 v64, v129, v113
  v_fmac_f32 v65, v129, v121
  v_fmac_f32 v64, v130, v114
  v_fmac_f32 v65, v130, v122
  v_fmac_f32 v64, v131, v115
  v_fmac_f32 v65, v131, v123
  v_fmac_f32 v64, v132, v116
  v_fmac_f32 v65, v132, v124
  v_fmac_f32 v64, v133, v117
  v_fmac_f32 v65, v133, v125
  v_fmac_f32 v64, v134, v118
  v_fmac_f32 v65, v134, v126
  v_fmac_f32 v64, v135, v119
  v_fmac_f32 v65, v135, v127
  s_nop 1
  v_add_f32_dpp v64, v64, v64 quad_perm:[1,0,3,2] row_mask:0xf bank_mask:0xf
  s_nop 1
  v_add_f32_dpp v64, v64, v64 quad_perm:[2,3,0,1] row_mask:0xf bank_mask:0xf
  s_nop 1
  v_add_f32_dpp v64, v64, v64 row_ror:4 row_mask:0xf bank_mask:0xf
  s_nop 1
  v_add_f32_dpp v64, v64, v64 row_ror:8 row_mask:0xf bank_mask:0xf
  v_mov_b32 v140, v64
  s_nop 1
  v_permlane32_swap_b32 v140, v64
  s_nop 1
  v_add_f32 v64, v64, v140
  v_mov_b32 v140, v64
  s_nop 1
  v_permlane16_swap_b32 v140, v64
  s_nop 1
  v_add_f32 v64, v64, v140
  s_nop 1
  v_add_f32_dpp v65, v65, v65 quad_perm:[1,0,3,2] row_mask:0xf bank_mask:0xf
  s_nop 1
  v_add_f32_dpp v65, v65, v65 quad_perm:[2,3,0,1] row_mask:0xf bank_mask:0xf
  s_nop 1
  v_add_f32_dpp v65, v65, v65 row_ror:4 row_mask:0xf bank_mask:0xf
  s_nop 1
  v_add_f32_dpp v65, v65, v65 row_ror:8 row_mask:0xf bank_mask:0xf
  v_mov_b32 v140, v65
  s_nop 1
  v_permlane32_swap_b32 v140, v65
  s_nop 1
  v_add_f32 v65, v65, v140
  v_mov_b32 v140, v65
  s_nop 1
  v_permlane16_swap_b32 v140, v65
  s_nop 1
  v_add_f32 v65, v65, v140
  v_mul_f32 v64, 0xbfb8aa3b, v64
  v_exp_f32 v64, v64
  s_nop 0
  v_add_f32 v64, 1.0, v64
  v_rcp_f32 v64, v64
  s_nop 0
  v_mul_f32 v65, 0xbfb8aa3b, v65
  v_exp_f32 v65, v65
  s_nop 0
  v_add_f32 v65, 1.0, v65
  v_rcp_f32 v65, v65
  s_nop 0
  s_mov_b32 s98, 0
W_10:
  ds_read_b32 v140, v3 offset:28
  s_waitcnt lgkmcnt(0)
  v_readfirstlane_b32 s99, v140
  s_cmp_ge_u32 s99, 1
  s_cbranch_scc1 WD_11
  s_sleep 4
  s_add_u32 s98, s98, 1
  s_cmp_lt_u32 s98, 1048576
  s_cbranch_scc1 W_10
WD_11:
  s_mov_b32 s97, 0
P_12:
  buffer_load_dwordx4 v[40:43], v138, s[60:63], s87 offen offset:0 sc1
  buffer_load_dwordx4 v[44:47], v138, s[60:63], s87 offen offset:64 sc1
  buffer_load_dwordx4 v[48:51], v138, s[60:63], s87 offen offset:128 sc1
  buffer_load_dwordx4 v[52:55], v138, s[60:63], s87 offen offset:192 sc1
  buffer_load_dwordx4 v[56:59], v138, s[60:63], s87 offen offset:256 sc1
  s_waitcnt vmcnt(0)
  v_xor_b32 v140, v136, v40
  v_xor_b32 v141, v136, v41
  v_xor_b32 v139, v136, v42
  v_or3_b32 v140, v140, v141, v139
  v_xor_b32 v141, v136, v43
  v_xor_b32 v139, v136, v44
  v_or3_b32 v140, v140, v141, v139
  v_xor_b32 v141, v136, v45
  v_xor_b32 v139, v136, v46
  v_or3_b32 v140, v140, v141, v139
  v_xor_b32 v141, v136, v47
  v_xor_b32 v139, v136, v48
  v_or3_b32 v140, v140, v141, v139
  v_xor_b32 v141, v136, v49
  v_xor_b32 v139, v136, v50
  v_or3_b32 v140, v140, v141, v139
  v_xor_b32 v141, v136, v51
  v_xor_b32 v139, v136, v52
  v_or3_b32 v140, v140, v141, v139
  v_xor_b32 v141, v136, v53
  v_xor_b32 v139, v136, v54
  v_or3_b32 v140, v140, v141, v139
  v_xor_b32 v141, v136, v55
  v_xor_b32 v139, v136, v56
  v_or3_b32 v140, v140, v141, v139
  v_xor_b32 v141, v136, v57
  v_xor_b32 v139, v136, v58
  v_or3_b32 v140, v140, v141, v139
  v_xor_b32 v141, v136, v59
  v_or_b32 v140, v140, v141
  v_and_b32 v140, s31, v140
  v_cmp_ne_u32 vcc, 0, v140
  s_cmp_eq_u64 vcc, 0
  s_cbranch_scc1 PD_13
  s_add_u32 s97, s97, 1
  s_cmp_lt_u32 s97, 65536
  s_cbranch_scc1 P_12
PD_13:
  s_nop 1
  v_add_f32_dpp v40, v40, v40 quad_perm:[1,0,3,2] row_mask:0xf bank_mask:0xf
  v_add_f32_dpp v41, v41, v41 quad_perm:[1,0,3,2] row_mask:0xf bank_mask:0xf
  v_add_f32_dpp v42, v42, v42 quad_perm:[1,0,3,2] row_mask:0xf bank_mask:0xf
  v_add_f32_dpp v43, v43, v43 quad_perm:[1,0,3,2] row_mask:0xf bank_mask:0xf
  v_add_f32_dpp v44, v44, v44 quad_perm:[1,0,3,2] row_mask:0xf bank_mask:0xf
  v_add_f32_dpp v45, v45, v45 quad_perm:[1,0,3,2] row_mask:0xf bank_mask:0xf
  v_add_f32_dpp v46, v46, v46 quad_perm:[1,0,3,2] row_mask:0xf bank_mask:0xf
  v_add_f32_dpp v47, v47, v47 quad_perm:[1,0,3,2] row_mask:0xf bank_mask:0xf
  v_add_f32_dpp v48, v48, v48 quad_perm:[1,0,3,2] row_mask:0xf bank_mask:0xf
  v_add_f32_dpp v49, v49, v49 quad_perm:[1,0,3,2] row_mask:0xf bank_mask:0xf
  v_add_f32_dpp v50, v50, v50 quad_perm:[1,0,3,2] row_mask:0xf bank_mask:0xf
  v_add_f32_dpp v51, v51, v51 quad_perm:[1,0,3,2] row_mask:0xf bank_mask:0xf
  v_add_f32_dpp v52, v52, v52 quad_perm:[1,0,3,2] row_mask:0xf bank_mask:0xf
  v_add_f32_dpp v53, v53, v53 quad_perm:[1,0,3,2] row_mask:0xf bank_mask:0xf
  v_add_f32_dpp v54, v54, v54 quad_perm:[1,0,3,2] row_mask:0xf bank_mask:0xf
  v_add_f32_dpp v55, v55, v55 quad_perm:[1,0,3,2] row_mask:0xf bank_mask:0xf
  v_add_f32_dpp v56, v56, v56 quad_perm:[1,0,3,2] row_mask:0xf bank_mask:0xf
  v_add_f32_dpp v57, v57, v57 quad_perm:[1,0,3,2] row_mask:0xf bank_mask:0xf
  v_add_f32_dpp v58, v58, v58 quad_perm:[1,0,3,2] row_mask:0xf bank_mask:0xf
  v_add_f32_dpp v59, v59, v59 quad_perm:[1,0,3,2] row_mask:0xf bank_mask:0xf
  s_nop 1
  v_add_f32_dpp v40, v40, v40 quad_perm:[2,3,0,1] row_mask:0xf bank_mask:0xf
  v_add_f32_dpp v41, v41, v41 quad_perm:[2,3,0,1] row_mask:0xf bank_mask:0xf
  v_add_f32_dpp v42, v42, v42 quad_perm:[2,3,0,1] row_mask:0xf bank_mask:0xf
  v_add_f32_dpp v43, v43, v43 quad_perm:[2,3,0,1] row_mask:0xf bank_mask:0xf
  v_add_f32_dpp v44, v44, v44 quad_perm:[2,3,0,1] row_mask:0xf bank_mask:0xf
  v_add_f32_dpp v45, v45, v45 quad_perm:[2,3,0,1] row_mask:0xf bank_mask:0xf
  v_add_f32_dpp v46, v46, v46 quad_perm:[2,3,0,1] row_mask:0xf bank_mask:0xf
  v_add_f32_dpp v47, v47, v47 quad_perm:[2,3,0,1] row_mask:0xf bank_mask:0xf
  v_add_f32_dpp v48, v48, v48 quad_perm:[2,3,0,1] row_mask:0xf bank_mask:0xf
  v_add_f32_dpp v49, v49, v49 quad_perm:[2,3,0,1] row_mask:0xf bank_mask:0xf
  v_add_f32_dpp v50, v50, v50 quad_perm:[2,3,0,1] row_mask:0xf bank_mask:0xf
  v_add_f32_dpp v51, v51, v51 quad_perm:[2,3,0,1] row_mask:0xf bank_mask:0xf
  v_add_f32_dpp v52, v52, v52 quad_perm:[2,3,0,1] row_mask:0xf bank_mask:0xf
  v_add_f32_dpp v53, v53, v53 quad_perm:[2,3,0,1] row_mask:0xf bank_mask:0xf
  v_add_f32_dpp v54, v54, v54 quad_perm:[2,3,0,1] row_mask:0xf bank_mask:0xf
  v_add_f32_dpp v55, v55, v55 quad_perm:[2,3,0,1] row_mask:0xf bank_mask:0xf
  v_add_f32_dpp v56, v56, v56 quad_perm:[2,3,0,1] row_mask:0xf bank_mask:0xf
  v_add_f32_dpp v57, v57, v57 quad_perm:[2,3,0,1] row_mask:0xf bank_mask:0xf
  v_add_f32_dpp v58, v58, v58 quad_perm:[2,3,0,1] row_mask:0xf bank_mask:0xf
  v_add_f32_dpp v59, v59, v59 quad_perm:[2,3,0,1] row_mask:0xf bank_mask:0xf
  s_nop 1
  v_add_f32_dpp v40, v40, v40 row_ror:4 row_mask:0xf bank_mask:0xf
  v_add_f32_dpp v41, v41, v41 row_ror:4 row_mask:0xf bank_mask:0xf
  v_add_f32_dpp v42, v42, v42 row_ror:4 row_mask:0xf bank_mask:0xf
  v_add_f32_dpp v43, v43, v43 row_ror:4 row_mask:0xf bank_mask:0xf
  v_add_f32_dpp v44, v44, v44 row_ror:4 row_mask:0xf bank_mask:0xf
  v_add_f32_dpp v45, v45, v45 row_ror:4 row_mask:0xf bank_mask:0xf
  v_add_f32_dpp v46, v46, v46 row_ror:4 row_mask:0xf bank_mask:0xf
  v_add_f32_dpp v47, v47, v47 row_ror:4 row_mask:0xf bank_mask:0xf
  v_add_f32_dpp v48, v48, v48 row_ror:4 row_mask:0xf bank_mask:0xf
  v_add_f32_dpp v49, v49, v49 row_ror:4 row_mask:0xf bank_mask:0xf
  v_add_f32_dpp v50, v50, v50 row_ror:4 row_mask:0xf bank_mask:0xf
  v_add_f32_dpp v51, v51, v51 row_ror:4 row_mask:0xf bank_mask:0xf
  v_add_f32_dpp v52, v52, v52 row_ror:4 row_mask:0xf bank_mask:0xf
  v_add_f32_dpp v53, v53, v53 row_ror:4 row_mask:0xf bank_mask:0xf
  v_add_f32_dpp v54, v54, v54 row_ror:4 row_mask:0xf bank_mask:0xf
  v_add_f32_dpp v55, v55, v55 row_ror:4 row_mask:0xf bank_mask:0xf
  v_add_f32_dpp v56, v56, v56 row_ror:4 row_mask:0xf bank_mask:0xf
  v_add_f32_dpp v57, v57, v57 row_ror:4 row_mask:0xf bank_mask:0xf
  v_add_f32_dpp v58, v58, v58 row_ror:4 row_mask:0xf bank_mask:0xf
  v_add_f32_dpp v59, v59, v59 row_ror:4 row_mask:0xf bank_mask:0xf
  s_nop 1
  v_add_f32_dpp v40, v40, v40 row_ror:8 row_mask:0xf bank_mask:0xf
  v_add_f32_dpp v41, v41, v41 row_ror:8 row_mask:0xf bank_mask:0xf
  v_add_f32_dpp v42, v42, v42 row_ror:8 row_mask:0xf bank_mask:0xf
  v_add_f32_dpp v43, v43, v43 row_ror:8 row_mask:0xf bank_mask:0xf
  v_add_f32_dpp v44, v44, v44 row_ror:8 row_mask:0xf bank_mask:0xf
  v_add_f32_dpp v45, v45, v45 row_ror:8 row_mask:0xf bank_mask:0xf
  v_add_f32_dpp v46, v46, v46 row_ror:8 row_mask:0xf bank_mask:0xf
  v_add_f32_dpp v47, v47, v47 row_ror:8 row_mask:0xf bank_mask:0xf
  v_add_f32_dpp v48, v48, v48 row_ror:8 row_mask:0xf bank_mask:0xf
  v_add_f32_dpp v49, v49, v49 row_ror:8 row_mask:0xf bank_mask:0xf
  v_add_f32_dpp v50, v50, v50 row_ror:8 row_mask:0xf bank_mask:0xf
  v_add_f32_dpp v51, v51, v51 row_ror:8 row_mask:0xf bank_mask:0xf
  v_add_f32_dpp v52, v52, v52 row_ror:8 row_mask:0xf bank_mask:0xf
  v_add_f32_dpp v53, v53, v53 row_ror:8 row_mask:0xf bank_mask:0xf
  v_add_f32_dpp v54, v54, v54 row_ror:8 row_mask:0xf bank_mask:0xf
  v_add_f32_dpp v55, v55, v55 row_ror:8 row_mask:0xf bank_mask:0xf
  v_add_f32_dpp v56, v56, v56 row_ror:8 row_mask:0xf bank_mask:0xf
  v_add_f32_dpp v57, v57, v57 row_ror:8 row_mask:0xf bank_mask:0xf
  v_add_f32_dpp v58, v58, v58 row_ror:8 row_mask:0xf bank_mask:0xf
  v_add_f32_dpp v59, v59, v59 row_ror:8 row_mask:0xf bank_mask:0xf
  v_lshrrev_b32 v140, 4, v0
  v_lshlrev_b32 v140, 4, v140
  s_mov_b32 exec_lo, 0x00010001
  s_mov_b32 exec_hi, 0x00010001
  ds_write_b128 v140, v[40:43] offset:1024
  ds_write_b128 v140, v[44:47] offset:1088
  ds_write_b128 v140, v[48:51] offset:1152
  ds_write_b128 v140, v[52:55] offset:1216
  ds_write_b128 v140, v[56:59] offset:1280
  s_mov_b64 exec, -1
  v_cmp_le_u32 vcc, 18, v0
  v_mov_b32 v140, 0
  v_mov_b32 v141, 1
  v_cndmask_b32 v140, v140, v141, vcc
  v_mul_u32_u24 v141, 18, v140
  v_sub_u32 v141, v0, v141
  v_lshlrev_b32 v141, 2, v141
  v_mul_u32_u24 v139, 80, v140
  v_add_u32 v139, v139, v141
  v_mul_u32_u24 v143, 96, v140
  v_add_u32 v143, v143, v141
  v_cndmask_b32 v140, v64, v65, vcc
  v_sub_f32 v140, 1.0, v140
  s_waitcnt lgkmcnt(0)
  s_mov_b32 exec_lo, -1
  s_mov_b32 exec_hi, 15
  ds_read_b32 v40, v139 offset:1024
  ds_read_b32 v41, v139 offset:1184
  s_waitcnt lgkmcnt(0)
  v_mul_f32 v42, 0xbfb8aa3b, v40
  v_exp_f32 v42, v42
  s_nop 0
  v_add_f32 v42, 1.0, v42
  v_rcp_f32 v42, v42
  s_nop 0
  v_mul_f32 v42, v42, v40
  v_mul_f32 v42, v42, v41
  v_mul_f32 v42, v42, v140
  ds_write_b32 v143, v42 offset:320
  s_mov_b64 exec, -1
  s_waitcnt lgkmcnt(0)
  s_mov_b64 exec, 1
  ds_add_u32 v3, v137 offset:12
  s_mov_b64 exec, -1
  s_mul_i32 s88, s84, 17408
  s_add_u32 s88, s88, 1835008
  s_lshl_b32 s87, s85, 6
  s_add_u32 s87, s87, s88
  s_lshr_b32 s89, s85, 3
  s_lshl_b32 s89, s89, 4
  s_add_u32 s88, s88, s89
  v_and_b32 v141, 15, v0
  v_mul_u32_u24 v141, 1088, v141
  v_and_b32 v138, 48, v0
  v_add_u32 v138, v138, v141
  v_and_b32 v139, 8, v0
  v_cmp_ne_u32 vcc, 0, v139
  v_mul_u32_u24 v139, 12, v139
  v_lshrrev_b32 v143, 4, v0
  v_lshl_add_u32 v139, v143, 4, v139
  v_cndmask_b32 v143, v64, v65, vcc
  s_mov_b32 s98, 0
W_14:
  ds_read_b32 v140, v3 offset:16
  s_waitcnt lgkmcnt(0)
  v_readfirstlane_b32 s99, v140
  s_cmp_ge_u32 s99, 8
  s_cbranch_scc1 WD_15
  s_sleep 1
  s_add_u32 s98, s98, 1
  s_cmp_lt_u32 s98, 1048576
  s_cbranch_scc1 W_14
WD_15:
  buffer_load_dwordx4 v[8:11], v138, s[60:63], s87 offen sc1
  buffer_load_dwordx4 v[12:15], v141, s[60:63], s88 offen offset:1024 sc1
  s_mov_b32 s97, 0
MP_16:
  s_waitcnt vmcnt(0)
  v_xor_b32 v140, v136, v8
  v_xor_b32 v60, v136, v9
  v_xor_b32 v61, v136, v10
  v_or3_b32 v140, v140, v60, v61
  v_xor_b32 v60, v136, v11
  v_xor_b32 v61, v136, v12
  v_or3_b32 v140, v140, v60, v61
  v_xor_b32 v60, v136, v13
  v_xor_b32 v61, v136, v14
  v_or3_b32 v140, v140, v60, v61
  v_xor_b32 v60, v136, v15
  v_or_b32 v140, v140, v60
  v_and_b32 v140, s31, v140
  v_cmp_ne_u32 vcc, 0, v140
  s_cmp_eq_u64 vcc, 0
  s_cbranch_scc1 MPD_18
  buffer_load_dwordx4 v[8:11], v138, s[60:63], s87 offen sc1
  buffer_load_dwordx4 v[12:15], v141, s[60:63], s88 offen offset:1024 sc1
  s_add_u32 s97, s97, 1
  s_cmp_lt_u32 s97, 65536
  s_cbranch_scc1 MP_16
  s_branch MPF_17
MPD_18:
MPF_17:
  s_mov_b32 s17, 1
L_ocomp:
  v_mov_b32 v14, v12
  s_nop 1
  v_max_f32_dpp v14, v14, v14 quad_perm:[1,0,3,2] row_mask:0xf bank_mask:0xf
  s_nop 1
  v_max_f32_dpp v14, v14, v14 quad_perm:[2,3,0,1] row_mask:0xf bank_mask:0xf
  s_nop 1
  v_max_f32_dpp v14, v14, v14 row_half_mirror row_mask:0xf bank_mask:0xf
  v_sub_f32 v12, v12, v14
  v_exp_f32 v12, v12
  s_nop 0
  v_mul_f32 v8, v8, v12
  v_mul_f32 v9, v9, v12
  v_mul_f32 v10, v10, v12
  v_mul_f32 v11, v11, v12
  v_mul_f32 v13, v13, v12
  s_nop 1
  v_add_f32_dpp v8, v8, v8 quad_perm:[1,0,3,2] row_mask:0xf bank_mask:0xf
  v_add_f32_dpp v9, v9, v9 quad_perm:[1,0,3,2] row_mask:0xf bank_mask:0xf
  v_add_f32_dpp v10, v10, v10 quad_perm:[1,0,3,2] row_mask:0xf bank_mask:0xf
  v_add_f32_dpp v11, v11, v11 quad_perm:[1,0,3,2] row_mask:0xf bank_mask:0xf
  v_add_f32_dpp v13, v13, v13 quad_perm:[1,0,3,2] row_mask:0xf bank_mask:0xf
  s_nop 1
  v_add_f32_dpp v8, v8, v8 quad_perm:[2,3,0,1] row_mask:0xf bank_mask:0xf
  v_add_f32_dpp v9, v9, v9 quad_perm:[2,3,0,1] row_mask:0xf bank_mask:0xf
  v_add_f32_dpp v10, v10, v10 quad_perm:[2,3,0,1] row_mask:0xf bank_mask:0xf
  v_add_f32_dpp v11, v11, v11 quad_perm:[2,3,0,1] row_mask:0xf bank_mask:0xf
  v_add_f32_dpp v13, v13, v13 quad_perm:[2,3,0,1] row_mask:0xf bank_mask:0xf
  s_nop 1
  v_add_f32_dpp v8, v8, v8 row_half_mirror row_mask:0xf bank_mask:0xf
  v_add_f32_dpp v9, v9, v9 row_half_mirror row_mask:0xf bank_mask:0xf
  v_add_f32_dpp v10, v10, v10 row_half_mirror row_mask:0xf bank_mask:0xf
  v_add_f32_dpp v11, v11, v11 row_half_mirror row_mask:0xf bank_mask:0xf
  v_add_f32_dpp v13, v13, v13 row_half_mirror row_mask:0xf bank_mask:0xf
  v_rcp_f32 v13, v13
  s_nop 0
  v_mul_f32 v13, v13, v143
  v_mul_f32 v8, v8, v13
  v_mul_f32 v9, v9, v13
  v_mul_f32 v10, v10, v13
  v_mul_f32 v11, v11, v13
  s_mov_b32 exec_lo, 0x01010101
  s_mov_b32 exec_hi, 0x01010101
  ds_write_b128 v139, v[8:11] offset:128
  s_mov_b64 exec, -1
  s_waitcnt lgkmcnt(0)
  s_mov_b64 exec, 1
  ds_add_u32 v3, v146 offset:20
  s_mov_b64 exec, -1
L_aux_final:
  s_cmp_ge_u32 s2, 72
  s_cbranch_scc1 L_aux_end
  v_lshrrev_b32 v138, 2, v0
  v_mul_u32_u24 v138, 4608, v138
  v_and_b32 v139, 48, v142
  v_add_u32 v138, v138, v139
  s_mul_i32 s87, s86, 73728
  s_lshl_b32 s88, s2, 6
  s_add_u32 s87, s87, s88
  s_add_u32 s87, s87, 2162688
  s_add_u32 s88, s87, 294912
  s_add_u32 s89, s87, 589824
  s_add_u32 s90, s87, 884736
L_fpoll:
  s_mov_b32 s98, 0
W_19:
  ds_read_b32 v140, v3 offset:20
  s_waitcnt lgkmcnt(0)
  v_readfirstlane_b32 s99, v140
  s_cmp_ge_u32 s99, 1
  s_cbranch_scc1 WD_20
  s_sleep 1
  s_add_u32 s98, s98, 1
  s_cmp_lt_u32 s98, 1048576
  s_cbranch_scc1 W_19
WD_20:
  s_sleep 32
  buffer_load_dwordx4 v[8:11], v138, s[60:63], s87 offen sc1
  buffer_load_dwordx4 v[12:15], v138, s[60:63], s88 offen sc1
  buffer_load_dwordx4 v[16:19], v138, s[60:63], s89 offen sc1
  buffer_load_dwordx4 v[20:23], v138, s[60:63], s90 offen sc1
  s_mov_b32 s97, 0
MP_21:
  s_waitcnt vmcnt(0)
  v_xor_b32 v140, v136, v8
  v_xor_b32 v141, v136, v9
  v_xor_b32 v139, v136, v10
  v_or3_b32 v140, v140, v141, v139
  v_xor_b32 v141, v136, v11
  v_xor_b32 v139, v136, v12
  v_or3_b32 v140, v140, v141, v139
  v_xor_b32 v141, v136, v13
  v_xor_b32 v139, v136, v14
  v_or3_b32 v140, v140, v141, v139
  v_xor_b32 v141, v136, v15
  v_xor_b32 v139, v136, v16
  v_or3_b32 v140, v140, v141, v139
  v_xor_b32 v141, v136, v17
  v_xor_b32 v139, v136, v18
  v_or3_b32 v140, v140, v141, v139
  v_xor_b32 v141, v136, v19
  v_xor_b32 v139, v136, v20
  v_or3_b32 v140, v140, v141, v139
  v_xor_b32 v141, v136, v21
  v_xor_b32 v139, v136, v22
  v_or3_b32 v140, v140, v141, v139
  v_xor_b32 v141, v136, v23
  v_or_b32 v140, v140, v141
  v_and_b32 v140, s31, v140
  v_cmp_ne_u32 vcc, 0, v140
  s_cmp_eq_u64 vcc, 0
  s_cbranch_scc1 MPD_23
  buffer_load_dwordx4 v[8:11], v138, s[60:63], s87 offen sc1
  buffer_load_dwordx4 v[12:15], v138, s[60:63], s88 offen sc1
  buffer_load_dwordx4 v[16:19], v138, s[60:63], s89 offen sc1
  buffer_load_dwordx4 v[20:23], v138, s[60:63], s90 offen sc1
  s_add_u32 s97, s97, 1
  s_cmp_lt_u32 s97, 65536
  s_cbranch_scc1 MP_21
  s_branch MPF_22
MPD_23:
MPF_22:
L_fcomp:
  v_add_f32 v8, v8, v12
  v_add_f32 v16, v16, v20
  v_add_f32 v9, v9, v13
  v_add_f32 v17, v17, v21
  v_add_f32 v10, v10, v14
  v_add_f32 v18, v18, v22
  v_add_f32 v11, v11, v15
  v_add_f32 v19, v19, v23
  v_add_f32 v8, v8, v16
  v_add_f32 v9, v9, v17
  v_add_f32 v10, v10, v18
  v_add_f32 v11, v11, v19
  s_nop 1
  v_add_f32_dpp v8, v8, v8 row_ror:4 row_mask:0xf bank_mask:0xf
  v_add_f32_dpp v9, v9, v9 row_ror:4 row_mask:0xf bank_mask:0xf
  v_add_f32_dpp v10, v10, v10 row_ror:4 row_mask:0xf bank_mask:0xf
  v_add_f32_dpp v11, v11, v11 row_ror:4 row_mask:0xf bank_mask:0xf
  s_nop 1
  v_add_f32_dpp v8, v8, v8 row_ror:8 row_mask:0xf bank_mask:0xf
  v_add_f32_dpp v9, v9, v9 row_ror:8 row_mask:0xf bank_mask:0xf
  v_add_f32_dpp v10, v10, v10 row_ror:8 row_mask:0xf bank_mask:0xf
  v_add_f32_dpp v11, v11, v11 row_ror:8 row_mask:0xf bank_mask:0xf
  s_nop 1
  v_permlane32_swap_b32 v8, v10
  v_permlane32_swap_b32 v9, v11
  s_nop 1
  v_add_f32 v8, v8, v10
  v_add_f32 v9, v9, v11
  s_nop 1
  v_permlane16_swap_b32 v8, v9
  s_nop 1
  v_add_f32 v8, v8, v9
  v_and_b32 v140, 3, v0
  v_lshlrev_b32 v140, 4, v140
  v_lshrrev_b32 v141, 4, v0
  v_lshl_add_u32 v140, v141, 2, v140
  s_lshl_b32 s91, s86, 6
  v_add_u32 v140, s91, v140
  s_mov_b32 exec_lo, 0x000f000f
  s_mov_b32 exec_hi, 0x000f000f
  ds_write_b32 v140, v8 offset:1536
  s_waitcnt lgkmcnt(0)
  s_mov_b64 exec, 1
  ds_add_rtn_u32 v141, v3, v137 offset:24
  s_waitcnt lgkmcnt(0)
  v_readfirstlane_b32 s99, v141
  s_mov_b64 exec, -1
  s_cmp_lg_u32 s99, 3
  s_cbranch_scc1 L_aux_end
L_flast:
  s_mov_b64 exec, 15
  ds_read_b128 v[8:11], v142 offset:1536
  ds_read_b128 v[12:15], v142 offset:1600
  ds_read_b128 v[16:19], v142 offset:1664
  ds_read_b128 v[20:23], v142 offset:1728
  s_waitcnt lgkmcnt(0)
  v_add_f32 v8, v8, v12
  v_add_f32 v16, v16, v20
  v_add_f32 v9, v9, v13
  v_add_f32 v17, v17, v21
  v_add_f32 v10, v10, v14
  v_add_f32 v18, v18, v22
  v_add_f32 v11, v11, v15
  v_add_f32 v19, v19, v23
  v_add_f32 v8, v8, v16
  v_add_f32 v9, v9, v17
  v_add_f32 v10, v10, v18
  v_add_f32 v11, v11, v19
  v_cvt_pk_bf16_f32 v12, v8, v9
  v_cvt_pk_bf16_f32 v13, v10, v11
  v_lshlrev_b32 v140, 3, v0
  s_lshl_b32 s91, s2, 5
  buffer_store_dwordx2 v[12:13], v140, s[64:67], s91 offen
  s_cmp_lg_u32 s2, 0
  s_cbranch_scc1 L_aux_end
  s_mov_b64 exec, 1
  v_mov_b32 v141, s30
  v_mov_b32 v142, 3342336
  buffer_store_dword v141, v142, s[60:63], 0 offen
L_aux_end:
  s_endpgm
L_kv:
  v_and_b32 v164, 15, v0
  v_lshrrev_b32 v165, 4, v0
  v_lshlrev_b32 v1, 8, v164
  v_lshl_add_u32 v1, v165, 4, v1
  v_lshlrev_b32 v2, 10, v165
  v_lshl_add_u32 v2, v164, 4, v2
  v_mov_b32 v3, 0
  v_mov_b32 v4, 0
  v_mov_b32 v5, 0
  v_mov_b32 v6, 0
  v_mov_b32 v7, 0
  v_mov_b32 v8, 0
  v_mov_b32 v9, 0
  v_mov_b32 v10, 0
  v_mov_b32 v11, 0
  v_mov_b32 v12, 0
  v_mov_b32 v13, 0
  v_mov_b32 v14, 0
  v_mov_b32 v15, 0
  v_mov_b32 v16, 0
  v_mov_b32 v17, 0
  v_mov_b32 v18, 0
  v_mov_b32 v19, 0
  s_lshr_b32 s86, s85, 3
  s_lshl_b32 s86, s86, 4
  s_add_u32 s86, s86, s84
  s_lshl_b32 s86, s86, 3
  s_and_b32 s87, s85, 7
  s_add_u32 s86, s86, s87
  s_lshl_b32 s86, s86, 3
  s_add_u32 s86, s86, s3
  s_lshl_b32 s4, s86, 14
  s_add_u32 s5, s4, 4096
  s_add_u32 s6, s4, 8192
  s_add_u32 s7, s4, 12288
  s_cmp_lg_u32 s3, 0
  s_cbranch_scc1 NI_1
  v_lshlrev_b32 v167, 4, v0
  ds_write_b128 v167, v[4:7]
  s_waitcnt lgkmcnt(0)
NI_1:
  s_barrier
  s_setprio 2
  buffer_load_dwordx4 v[36:39], v1, s[32:35], s4 offen offset:0 nt
  s_load_dword s30, s[76:77], 0
  buffer_load_dwordx4 v[40:43], v1, s[32:35], s4 offen offset:64 nt
  buffer_load_dwordx4 v[44:47], v1, s[32:35], s4 offen offset:128 nt
  buffer_load_dwordx4 v[48:51], v1, s[32:35], s4 offen offset:192 nt
  buffer_load_dwordx4 v[52:55], v1, s[32:35], s5 offen offset:0 nt
  buffer_load_dwordx4 v[56:59], v1, s[32:35], s5 offen offset:64 nt
  buffer_load_dwordx4 v[60:63], v1, s[32:35], s5 offen offset:128 nt
  buffer_load_dwordx4 v[64:67], v1, s[32:35], s5 offen offset:192 nt
  s_waitcnt vmcnt(7)
  buffer_load_dwordx4 v[68:71], v1, s[32:35], s6 offen offset:0 nt
  s_waitcnt vmcnt(7)
  buffer_load_dwordx4 v[72:75], v1, s[32:35], s6 offen offset:64 nt
  s_waitcnt vmcnt(7)
  buffer_load_dwordx4 v[76:79], v1, s[32:35], s6 offen offset:128 nt
  s_waitcnt vmcnt(7)
  buffer_load_dwordx4 v[80:83], v1, s[32:35], s6 offen offset:192 nt
  s_waitcnt vmcnt(7)
  buffer_load_dwordx4 v[84:87], v1, s[32:35], s7 offen offset:0 nt
  s_waitcnt vmcnt(7)
  buffer_load_dwordx4 v[88:91], v1, s[32:35], s7 offen offset:64 nt
  s_waitcnt vmcnt(7)
  buffer_load_dwordx4 v[92:95], v1, s[32:35], s7 offen offset:128 nt
  s_waitcnt vmcnt(7)
  buffer_load_dwordx4 v[96:99], v1, s[32:35], s7 offen offset:192 nt
  s_setprio 0
  s_waitcnt vmcnt(7)
  buffer_load_dwordx4 v[100:103], v2, s[36:39], s4 offen offset:0 nt
  s_waitcnt vmcnt(7)
  buffer_load_dwordx4 v[104:107], v2, s[36:39], s4 offen offset:256 nt
  s_waitcnt vmcnt(7)
  buffer_load_dwordx4 v[108:111], v2, s[36:39], s4 offen offset:512 nt
  s_waitcnt vmcnt(7)
  buffer_load_dwordx4 v[112:115], v2, s[36:39], s4 offen offset:768 nt
  s_waitcnt vmcnt(7)
  buffer_load_dwordx4 v[116:119], v2, s[36:39], s5 offen offset:0 nt
  s_waitcnt vmcnt(7)
  buffer_load_dwordx4 v[120:123], v2, s[36:39], s5 offen offset:256 nt
  s_waitcnt vmcnt(7)
  buffer_load_dwordx4 v[124:127], v2, s[36:39], s5 offen offset:512 nt
  s_mov_b32 s98, 0
W_2:
  ds_read_b32 v164, v3 offset:8
  s_waitcnt lgkmcnt(0)
  v_readfirstlane_b32 s99, v164
  s_cmp_ge_u32 s99, 1
  s_cbranch_scc1 WD_3
  s_sleep 2
  s_add_u32 s98, s98, 1
  s_cmp_lt_u32 s98, 1048576
  s_cbranch_scc1 W_2
WD_3:
  v_and_b32 v164, 15, v0
  v_lshrrev_b32 v165, 4, v0
  v_lshlrev_b32 v164, 8, v164
  v_lshl_add_u32 v164, v165, 4, v164
  s_mov_b32 exec_lo, 0x00030003
  s_mov_b32 exec_hi, 0x00030003
  ds_read_b128 v[4:7], v164 offset:512
  ds_read_b128 v[8:11], v164 offset:576
  ds_read_b128 v[12:15], v164 offset:640
  ds_read_b128 v[16:19], v164 offset:704
  s_mov_b64 exec, -1
  s_waitcnt vmcnt(7) lgkmcnt(0)
  v_mfma_f32_16x16x32_bf16 v[20:23], v[36:39], v[4:7], 0
  v_mfma_f32_16x16x32_bf16 v[24:27], v[52:55], v[4:7], 0
  v_mfma_f32_16x16x32_bf16 v[28:31], v[68:71], v[4:7], 0
  v_mfma_f32_16x16x32_bf16 v[32:35], v[84:87], v[4:7], 0
  v_mfma_f32_16x16x32_bf16 v[20:23], v[40:43], v[8:11], v[20:23]
  v_mfma_f32_16x16x32_bf16 v[24:27], v[56:59], v[8:11], v[24:27]
  v_mfma_f32_16x16x32_bf16 v[28:31], v[72:75], v[8:11], v[28:31]
  v_mfma_f32_16x16x32_bf16 v[32:35], v[88:91], v[8:11], v[32:35]
  v_mfma_f32_16x16x32_bf16 v[20:23], v[44:47], v[12:15], v[20:23]
  v_mfma_f32_16x16x32_bf16 v[24:27], v[60:63], v[12:15], v[24:27]
  v_mfma_f32_16x16x32_bf16 v[28:31], v[76:79], v[12:15], v[28:31]
  v_mfma_f32_16x16x32_bf16 v[32:35], v[92:95], v[12:15], v[32:35]
  v_mfma_f32_16x16x32_bf16 v[20:23], v[48:51], v[16:19], v[20:23]
  v_mfma_f32_16x16x32_bf16 v[24:27], v[64:67], v[16:19], v[24:27]
  v_mfma_f32_16x16x32_bf16 v[28:31], v[80:83], v[16:19], v[28:31]
  v_mfma_f32_16x16x32_bf16 v[32:35], v[96:99], v[16:19], v[32:35]
  s_add_u32 s15, s3, 4
  s_and_b32 s15, s15, 7
  s_lshl_b32 s87, s15, 8
  v_lshlrev_b32 v164, 2, v0
  v_add_u32 v164, s87, v164
  v_mov_b32 v165, 2147483648
  v_cmp_gt_u32 vcc, 1152, v164
  s_mul_i32 s8, s2, 20736
  s_mul_i32 s9, s2, 18432
  v_cndmask_b32 v166, v165, v164, vcc
  v_mov_b32 v99, v166
  v_lshlrev_b32 v167, 1, v164
  v_cndmask_b32 v98, v165, v167, vcc
  v_mov_b32 v96, 1
  s_add_u32 s30, s30, 1
  v_mov_b32 v97, s30
  v_and_b32 v97, s31, v97
  v_mov_b32 v70, 0
  v_mov_b32 v71, 0
  v_mov_b32 v72, 0
  v_mov_b32 v73, 0
  v_mov_b32 v74, 0
  v_mov_b32 v75, 0
  v_mov_b32 v76, 0
  v_mov_b32 v77, 0
  v_mov_b32 v78, 0
  v_mov_b32 v79, 0
  v_mov_b32 v80, 0
  v_mov_b32 v81, 0
  v_mov_b32 v82, 0
  v_mov_b32 v83, 0
  v_mov_b32 v84, 0
  v_mov_b32 v85, 0
  v_max3_f32 v94, v20, v21, v22
  v_max3_f32 v94, v94, v23, v24
  v_max3_f32 v94, v94, v25, v26
  v_max3_f32 v94, v94, v27, v28
  v_max3_f32 v94, v94, v29, v30
  v_max3_f32 v94, v94, v31, v32
  v_max3_f32 v94, v94, v33, v34
  v_max_f32 v94, v94, v35
  v_mov_b32 v164, v94
  s_nop 1
  v_permlane32_swap_b32 v164, v94
  s_nop 1
  v_max_f32 v94, v94, v164
  v_mov_b32 v164, v94
  s_nop 1
  v_permlane16_swap_b32 v164, v94
  s_nop 1
  v_max_f32 v94, v94, v164
  s_mov_b32 s14, 0x3e0293ee
  v_mul_f32 v94, s14, v94
  v_fma_f32 v20, v20, s14, -v94
  v_fma_f32 v21, v21, s14, -v94
  v_fma_f32 v22, v22, s14, -v94
  v_fma_f32 v23, v23, s14, -v94
  v_fma_f32 v24, v24, s14, -v94
  v_fma_f32 v25, v25, s14, -v94
  v_fma_f32 v26, v26, s14, -v94
  v_fma_f32 v27, v27, s14, -v94
  v_fma_f32 v28, v28, s14, -v94
  v_fma_f32 v29, v29, s14, -v94
  v_fma_f32 v30, v30, s14, -v94
  v_fma_f32 v31, v31, s14, -v94
  v_fma_f32 v32, v32, s14, -v94
  v_fma_f32 v33, v33, s14, -v94
  v_fma_f32 v34, v34, s14, -v94
  v_fma_f32 v35, v35, s14, -v94
  v_exp_f32 v20, v20
  v_exp_f32 v21, v21
  v_exp_f32 v22, v22
  v_exp_f32 v23, v23
  v_exp_f32 v24, v24
  v_exp_f32 v25, v25
  v_exp_f32 v26, v26
  v_exp_f32 v27, v27
  v_exp_f32 v28, v28
  v_exp_f32 v29, v29
  v_exp_f32 v30, v30
  v_exp_f32 v31, v31
  v_exp_f32 v32, v32
  v_exp_f32 v33, v33
  v_exp_f32 v34, v34
  v_exp_f32 v35, v35
  s_nop 0
  v_add_f32 v95, v20, v21
  v_add_f32 v95, v95, v22
  v_add_f32 v95, v95, v23
  v_add_f32 v95, v95, v24
  v_add_f32 v95, v95, v25
  v_add_f32 v95, v95, v26
  v_add_f32 v95, v95, v27
  v_add_f32 v95, v95, v28
  v_add_f32 v95, v95, v29
  v_add_f32 v95, v95, v30
  v_add_f32 v95, v95, v31
  v_add_f32 v95, v95, v32
  v_add_f32 v95, v95, v33
  v_add_f32 v95, v95, v34
  v_add_f32 v95, v95, v35
  v_mov_b32 v164, v95
  s_nop 1
  v_permlane32_swap_b32 v164, v95
  s_nop 1
  v_add_f32 v95, v95, v164
  v_mov_b32 v164, v95
  s_nop 1
  v_permlane16_swap_b32 v164, v95
  s_nop 1
  v_add_f32 v95, v95, v164
  v_lshrrev_b32 v4, 5, v0
  v_lshlrev_b32 v4, 9, v4
  v_and_b32 v165, 15, v0
  v_lshl_add_u32 v4, v165, 5, v4
  v_and_b32 v165, 16, v0
  v_add_u32 v4, v4, v165
  s_lshl_b32 s87, s3, 10
  v_add_u32 v4, s87, v4
  s_lshl_b32 s87, s3, 4
  v_lshlrev_b32 v5, 3, v0
  v_add_u32 v5, s87, v5
  s_mov_b64 exec, 3
  ds_write_b64 v5, v[94:95] offset:1408
  s_mov_b64 exec, 1
  ds_add_u32 v3, v96 offset:28
  s_mov_b64 exec, -1
  v_lshlrev_b32 v6, 4, v0
  v_lshrrev_b32 v7, 5, v0
  v_lshlrev_b32 v7, 3, v7
  v_lshlrev_b32 v9, 1, v7
  s_mul_i32 s10, s2, 1088
  s_add_u32 s10, s10, 1835008
  s_mul_i32 s12, s2, 4608
  s_add_u32 s12, s12, 2162688
  buffer_load_dwordx4 v[128:131], v2, s[36:39], s5 offen offset:768 nt
  s_waitcnt vmcnt(7)
  v_lshlrev_b32 v86, 16, v100
  v_and_b32 v87, 0xffff0000, v100
  v_lshlrev_b32 v88, 16, v101
  v_and_b32 v89, 0xffff0000, v101
  v_lshlrev_b32 v90, 16, v102
  v_and_b32 v91, 0xffff0000, v102
  v_lshlrev_b32 v92, 16, v103
  v_and_b32 v93, 0xffff0000, v103
  v_fmac_f32_dpp v70, v20, v86 row_newbcast:0 row_mask:0xf bank_mask:0xf
  v_fmac_f32_dpp v78, v20, v86 row_newbcast:1 row_mask:0xf bank_mask:0xf
  v_fmac_f32_dpp v71, v20, v87 row_newbcast:0 row_mask:0xf bank_mask:0xf
  v_fmac_f32_dpp v79, v20, v87 row_newbcast:1 row_mask:0xf bank_mask:0xf
  v_fmac_f32_dpp v72, v20, v88 row_newbcast:0 row_mask:0xf bank_mask:0xf
  v_fmac_f32_dpp v80, v20, v88 row_newbcast:1 row_mask:0xf bank_mask:0xf
  v_fmac_f32_dpp v73, v20, v89 row_newbcast:0 row_mask:0xf bank_mask:0xf
  v_fmac_f32_dpp v81, v20, v89 row_newbcast:1 row_mask:0xf bank_mask:0xf
  v_fmac_f32_dpp v74, v20, v90 row_newbcast:0 row_mask:0xf bank_mask:0xf
  v_fmac_f32_dpp v82, v20, v90 row_newbcast:1 row_mask:0xf bank_mask:0xf
  v_fmac_f32_dpp v75, v20, v91 row_newbcast:0 row_mask:0xf bank_mask:0xf
  v_fmac_f32_dpp v83, v20, v91 row_newbcast:1 row_mask:0xf bank_mask:0xf
  v_fmac_f32_dpp v76, v20, v92 row_newbcast:0 row_mask:0xf bank_mask:0xf
  v_fmac_f32_dpp v84, v20, v92 row_newbcast:1 row_mask:0xf bank_mask:0xf
  v_fmac_f32_dpp v77, v20, v93 row_newbcast:0 row_mask:0xf bank_mask:0xf
  v_fmac_f32_dpp v85, v20, v93 row_newbcast:1 row_mask:0xf bank_mask:0xf
  buffer_load_dwordx4 v[132:135], v2, s[36:39], s6 offen offset:0 nt
  s_waitcnt vmcnt(7)
  v_lshlrev_b32 v86, 16, v104
  v_and_b32 v87, 0xffff0000, v104
  v_lshlrev_b32 v88, 16, v105
  v_and_b32 v89, 0xffff0000, v105
  v_lshlrev_b32 v90, 16, v106
  v_and_b32 v91, 0xffff0000, v106
  v_lshlrev_b32 v92, 16, v107
  v_and_b32 v93, 0xffff0000, v107
  v_fmac_f32_dpp v70, v21, v86 row_newbcast:0 row_mask:0xf bank_mask:0xf
  v_fmac_f32_dpp v78, v21, v86 row_newbcast:1 row_mask:0xf bank_mask:0xf
  v_fmac_f32_dpp v71, v21, v87 row_newbcast:0 row_mask:0xf bank_mask:0xf
  v_fmac_f32_dpp v79, v21, v87 row_newbcast:1 row_mask:0xf bank_mask:0xf
  v_fmac_f32_dpp v72, v21, v88 row_newbcast:0 row_mask:0xf bank_mask:0xf
  v_fmac_f32_dpp v80, v21, v88 row_newbcast:1 row_mask:0xf bank_mask:0xf
  v_fmac_f32_dpp v73, v21, v89 row_newbcast:0 row_mask:0xf bank_mask:0xf
  v_fmac_f32_dpp v81, v21, v89 row_newbcast:1 row_mask:0xf bank_mask:0xf
  v_fmac_f32_dpp v74, v21, v90 row_newbcast:0 row_mask:0xf bank_mask:0xf
  v_fmac_f32_dpp v82, v21, v90 row_newbcast:1 row_mask:0xf bank_mask:0xf
  v_fmac_f32_dpp v75, v21, v91 row_newbcast:0 row_mask:0xf bank_mask:0xf
  v_fmac_f32_dpp v83, v21, v91 row_newbcast:1 row_mask:0xf bank_mask:0xf
  v_fmac_f32_dpp v76, v21, v92 row_newbcast:0 row_mask:0xf bank_mask:0xf
  v_fmac_f32_dpp v84, v21, v92 row_newbcast:1 row_mask:0xf bank_mask:0xf
  v_fmac_f32_dpp v77, v21, v93 row_newbcast:0 row_mask:0xf bank_mask:0xf
  v_fmac_f32_dpp v85, v21, v93 row_newbcast:1 row_mask:0xf bank_mask:0xf
  buffer_load_dwordx4 v[136:139], v2, s[36:39], s6 offen offset:256 nt
  s_waitcnt vmcnt(7)
  v_lshlrev_b32 v86, 16, v108
  v_and_b32 v87, 0xffff0000, v108
  v_lshlrev_b32 v88, 16, v109
  v_and_b32 v89, 0xffff0000, v109
  v_lshlrev_b32 v90, 16, v110
  v_and_b32 v91, 0xffff0000, v110
  v_lshlrev_b32 v92, 16, v111
  v_and_b32 v93, 0xffff0000, v111
  v_fmac_f32_dpp v70, v22, v86 row_newbcast:0 row_mask:0xf bank_mask:0xf
  v_fmac_f32_dpp v78, v22, v86 row_newbcast:1 row_mask:0xf bank_mask:0xf
  v_fmac_f32_dpp v71, v22, v87 row_newbcast:0 row_mask:0xf bank_mask:0xf
  v_fmac_f32_dpp v79, v22, v87 row_newbcast:1 row_mask:0xf bank_mask:0xf
  v_fmac_f32_dpp v72, v22, v88 row_newbcast:0 row_mask:0xf bank_mask:0xf
  v_fmac_f32_dpp v80, v22, v88 row_newbcast:1 row_mask:0xf bank_mask:0xf
  v_fmac_f32_dpp v73, v22, v89 row_newbcast:0 row_mask:0xf bank_mask:0xf
  v_fmac_f32_dpp v81, v22, v89 row_newbcast:1 row_mask:0xf bank_mask:0xf
  v_fmac_f32_dpp v74, v22, v90 row_newbcast:0 row_mask:0xf bank_mask:0xf
  v_fmac_f32_dpp v82, v22, v90 row_newbcast:1 row_mask:0xf bank_mask:0xf
  v_fmac_f32_dpp v75, v22, v91 row_newbcast:0 row_mask:0xf bank_mask:0xf
  v_fmac_f32_dpp v83, v22, v91 row_newbcast:1 row_mask:0xf bank_mask:0xf
  v_fmac_f32_dpp v76, v22, v92 row_newbcast:0 row_mask:0xf bank_mask:0xf
  v_fmac_f32_dpp v84, v22, v92 row_newbcast:1 row_mask:0xf bank_mask:0xf
  v_fmac_f32_dpp v77, v22, v93 row_newbcast:0 row_mask:0xf bank_mask:0xf
  v_fmac_f32_dpp v85, v22, v93 row_newbcast:1 row_mask:0xf bank_mask:0xf
  buffer_load_dwordx4 v[140:143], v2, s[36:39], s6 offen offset:512 nt
  s_waitcnt vmcnt(7)
  v_lshlrev_b32 v86, 16, v112
  v_and_b32 v87, 0xffff0000, v112
  v_lshlrev_b32 v88, 16, v113
  v_and_b32 v89, 0xffff0000, v113
  v_lshlrev_b32 v90, 16, v114
  v_and_b32 v91, 0xffff0000, v114
  v_lshlrev_b32 v92, 16, v115
  v_and_b32 v93, 0xffff0000, v115
  v_fmac_f32_dpp v70, v23, v86 row_newbcast:0 row_mask:0xf bank_mask:0xf
  v_fmac_f32_dpp v78, v23, v86 row_newbcast:1 row_mask:0xf bank_mask:0xf
  v_fmac_f32_dpp v71, v23, v87 row_newbcast:0 row_mask:0xf bank_mask:0xf
  v_fmac_f32_dpp v79, v23, v87 row_newbcast:1 row_mask:0xf bank_mask:0xf
  v_fmac_f32_dpp v72, v23, v88 row_newbcast:0 row_mask:0xf bank_mask:0xf
  v_fmac_f32_dpp v80, v23, v88 row_newbcast:1 row_mask:0xf bank_mask:0xf
  v_fmac_f32_dpp v73, v23, v89 row_newbcast:0 row_mask:0xf bank_mask:0xf
  v_fmac_f32_dpp v81, v23, v89 row_newbcast:1 row_mask:0xf bank_mask:0xf
  v_fmac_f32_dpp v74, v23, v90 row_newbcast:0 row_mask:0xf bank_mask:0xf
  v_fmac_f32_dpp v82, v23, v90 row_newbcast:1 row_mask:0xf bank_mask:0xf
  v_fmac_f32_dpp v75, v23, v91 row_newbcast:0 row_mask:0xf bank_mask:0xf
  v_fmac_f32_dpp v83, v23, v91 row_newbcast:1 row_mask:0xf bank_mask:0xf
  v_fmac_f32_dpp v76, v23, v92 row_newbcast:0 row_mask:0xf bank_mask:0xf
  v_fmac_f32_dpp v84, v23, v92 row_newbcast:1 row_mask:0xf bank_mask:0xf
  v_fmac_f32_dpp v77, v23, v93 row_newbcast:0 row_mask:0xf bank_mask:0xf
  v_fmac_f32_dpp v85, v23, v93 row_newbcast:1 row_mask:0xf bank_mask:0xf
  buffer_load_dwordx4 v[144:147], v2, s[36:39], s6 offen offset:768 nt
  s_waitcnt vmcnt(7)
  v_lshlrev_b32 v86, 16, v116
  v_and_b32 v87, 0xffff0000, v116
  v_lshlrev_b32 v88, 16, v117
  v_and_b32 v89, 0xffff0000, v117
  v_lshlrev_b32 v90, 16, v118
  v_and_b32 v91, 0xffff0000, v118
  v_lshlrev_b32 v92, 16, v119
  v_and_b32 v93, 0xffff0000, v119
  v_fmac_f32_dpp v70, v24, v86 row_newbcast:0 row_mask:0xf bank_mask:0xf
  v_fmac_f32_dpp v78, v24, v86 row_newbcast:1 row_mask:0xf bank_mask:0xf
  v_fmac_f32_dpp v71, v24, v87 row_newbcast:0 row_mask:0xf bank_mask:0xf
  v_fmac_f32_dpp v79, v24, v87 row_newbcast:1 row_mask:0xf bank_mask:0xf
  v_fmac_f32_dpp v72, v24, v88 row_newbcast:0 row_mask:0xf bank_mask:0xf
  v_fmac_f32_dpp v80, v24, v88 row_newbcast:1 row_mask:0xf bank_mask:0xf
  v_fmac_f32_dpp v73, v24, v89 row_newbcast:0 row_mask:0xf bank_mask:0xf
  v_fmac_f32_dpp v81, v24, v89 row_newbcast:1 row_mask:0xf bank_mask:0xf
  v_fmac_f32_dpp v74, v24, v90 row_newbcast:0 row_mask:0xf bank_mask:0xf
  v_fmac_f32_dpp v82, v24, v90 row_newbcast:1 row_mask:0xf bank_mask:0xf
  v_fmac_f32_dpp v75, v24, v91 row_newbcast:0 row_mask:0xf bank_mask:0xf
  v_fmac_f32_dpp v83, v24, v91 row_newbcast:1 row_mask:0xf bank_mask:0xf
  v_fmac_f32_dpp v76, v24, v92 row_newbcast:0 row_mask:0xf bank_mask:0xf
  v_fmac_f32_dpp v84, v24, v92 row_newbcast:1 row_mask:0xf bank_mask:0xf
  v_fmac_f32_dpp v77, v24, v93 row_newbcast:0 row_mask:0xf bank_mask:0xf
  v_fmac_f32_dpp v85, v24, v93 row_newbcast:1 row_mask:0xf bank_mask:0xf
  buffer_load_dwordx4 v[148:151], v2, s[36:39], s7 offen offset:0 nt
  s_waitcnt vmcnt(7)
  v_lshlrev_b32 v86, 16, v120
  v_and_b32 v87, 0xffff0000, v120
  v_lshlrev_b32 v88, 16, v121
  v_and_b32 v89, 0xffff0000, v121
  v_lshlrev_b32 v90, 16, v122
  v_and_b32 v91, 0xffff0000, v122
  v_lshlrev_b32 v92, 16, v123
  v_and_b32 v93, 0xffff0000, v123
  v_fmac_f32_dpp v70, v25, v86 row_newbcast:0 row_mask:0xf bank_mask:0xf
  v_fmac_f32_dpp v78, v25, v86 row_newbcast:1 row_mask:0xf bank_mask:0xf
  v_fmac_f32_dpp v71, v25, v87 row_newbcast:0 row_mask:0xf bank_mask:0xf
  v_fmac_f32_dpp v79, v25, v87 row_newbcast:1 row_mask:0xf bank_mask:0xf
  v_fmac_f32_dpp v72, v25, v88 row_newbcast:0 row_mask:0xf bank_mask:0xf
  v_fmac_f32_dpp v80, v25, v88 row_newbcast:1 row_mask:0xf bank_mask:0xf
  v_fmac_f32_dpp v73, v25, v89 row_newbcast:0 row_mask:0xf bank_mask:0xf
  v_fmac_f32_dpp v81, v25, v89 row_newbcast:1 row_mask:0xf bank_mask:0xf
  v_fmac_f32_dpp v74, v25, v90 row_newbcast:0 row_mask:0xf bank_mask:0xf
  v_fmac_f32_dpp v82, v25, v90 row_newbcast:1 row_mask:0xf bank_mask:0xf
  v_fmac_f32_dpp v75, v25, v91 row_newbcast:0 row_mask:0xf bank_mask:0xf
  v_fmac_f32_dpp v83, v25, v91 row_newbcast:1 row_mask:0xf bank_mask:0xf
  v_fmac_f32_dpp v76, v25, v92 row_newbcast:0 row_mask:0xf bank_mask:0xf
  v_fmac_f32_dpp v84, v25, v92 row_newbcast:1 row_mask:0xf bank_mask:0xf
  v_fmac_f32_dpp v77, v25, v93 row_newbcast:0 row_mask:0xf bank_mask:0xf
  v_fmac_f32_dpp v85, v25, v93 row_newbcast:1 row_mask:0xf bank_mask:0xf
  buffer_load_dwordx4 v[152:155], v2, s[36:39], s7 offen offset:256 nt
  s_waitcnt vmcnt(7)
  v_lshlrev_b32 v86, 16, v124
  v_and_b32 v87, 0xffff0000, v124
  v_lshlrev_b32 v88, 16, v125
  v_and_b32 v89, 0xffff0000, v125
  v_lshlrev_b32 v90, 16, v126
  v_and_b32 v91, 0xffff0000, v126
  v_lshlrev_b32 v92, 16, v127
  v_and_b32 v93, 0xffff0000, v127
  v_fmac_f32_dpp v70, v26, v86 row_newbcast:0 row_mask:0xf bank_mask:0xf
  v_fmac_f32_dpp v78, v26, v86 row_newbcast:1 row_mask:0xf bank_mask:0xf
  v_fmac_f32_dpp v71, v26, v87 row_newbcast:0 row_mask:0xf bank_mask:0xf
  v_fmac_f32_dpp v79, v26, v87 row_newbcast:1 row_mask:0xf bank_mask:0xf
  v_fmac_f32_dpp v72, v26, v88 row_newbcast:0 row_mask:0xf bank_mask:0xf
  v_fmac_f32_dpp v80, v26, v88 row_newbcast:1 row_mask:0xf bank_mask:0xf
  v_fmac_f32_dpp v73, v26, v89 row_newbcast:0 row_mask:0xf bank_mask:0xf
  v_fmac_f32_dpp v81, v26, v89 row_newbcast:1 row_mask:0xf bank_mask:0xf
  v_fmac_f32_dpp v74, v26, v90 row_newbcast:0 row_mask:0xf bank_mask:0xf
  v_fmac_f32_dpp v82, v26, v90 row_newbcast:1 row_mask:0xf bank_mask:0xf
  v_fmac_f32_dpp v75, v26, v91 row_newbcast:0 row_mask:0xf bank_mask:0xf
  v_fmac_f32_dpp v83, v26, v91 row_newbcast:1 row_mask:0xf bank_mask:0xf
  v_fmac_f32_dpp v76, v26, v92 row_newbcast:0 row_mask:0xf bank_mask:0xf
  v_fmac_f32_dpp v84, v26, v92 row_newbcast:1 row_mask:0xf bank_mask:0xf
  v_fmac_f32_dpp v77, v26, v93 row_newbcast:0 row_mask:0xf bank_mask:0xf
  v_fmac_f32_dpp v85, v26, v93 row_newbcast:1 row_mask:0xf bank_mask:0xf
  buffer_load_dwordx4 v[156:159], v2, s[36:39], s7 offen offset:512 nt
  s_waitcnt vmcnt(7)
  v_lshlrev_b32 v86, 16, v128
  v_and_b32 v87, 0xffff0000, v128
  v_lshlrev_b32 v88, 16, v129
  v_and_b32 v89, 0xffff0000, v129
  v_lshlrev_b32 v90, 16, v130
  v_and_b32 v91, 0xffff0000, v130
  v_lshlrev_b32 v92, 16, v131
  v_and_b32 v93, 0xffff0000, v131
  v_fmac_f32_dpp v70, v27, v86 row_newbcast:0 row_mask:0xf bank_mask:0xf
  v_fmac_f32_dpp v78, v27, v86 row_newbcast:1 row_mask:0xf bank_mask:0xf
  v_fmac_f32_dpp v71, v27, v87 row_newbcast:0 row_mask:0xf bank_mask:0xf
  v_fmac_f32_dpp v79, v27, v87 row_newbcast:1 row_mask:0xf bank_mask:0xf
  v_fmac_f32_dpp v72, v27, v88 row_newbcast:0 row_mask:0xf bank_mask:0xf
  v_fmac_f32_dpp v80, v27, v88 row_newbcast:1 row_mask:0xf bank_mask:0xf
  v_fmac_f32_dpp v73, v27, v89 row_newbcast:0 row_mask:0xf bank_mask:0xf
  v_fmac_f32_dpp v81, v27, v89 row_newbcast:1 row_mask:0xf bank_mask:0xf
  v_fmac_f32_dpp v74, v27, v90 row_newbcast:0 row_mask:0xf bank_mask:0xf
  v_fmac_f32_dpp v82, v27, v90 row_newbcast:1 row_mask:0xf bank_mask:0xf
  v_fmac_f32_dpp v75, v27, v91 row_newbcast:0 row_mask:0xf bank_mask:0xf
  v_fmac_f32_dpp v83, v27, v91 row_newbcast:1 row_mask:0xf bank_mask:0xf
  v_fmac_f32_dpp v76, v27, v92 row_newbcast:0 row_mask:0xf bank_mask:0xf
  v_fmac_f32_dpp v84, v27, v92 row_newbcast:1 row_mask:0xf bank_mask:0xf
  v_fmac_f32_dpp v77, v27, v93 row_newbcast:0 row_mask:0xf bank_mask:0xf
  v_fmac_f32_dpp v85, v27, v93 row_newbcast:1 row_mask:0xf bank_mask:0xf
  buffer_load_dwordx4 v[160:163], v2, s[36:39], s7 offen offset:768 nt
  s_waitcnt vmcnt(7)
  v_lshlrev_b32 v86, 16, v132
  v_and_b32 v87, 0xffff0000, v132
  v_lshlrev_b32 v88, 16, v133
  v_and_b32 v89, 0xffff0000, v133
  v_lshlrev_b32 v90, 16, v134
  v_and_b32 v91, 0xffff0000, v134
  v_lshlrev_b32 v92, 16, v135
  v_and_b32 v93, 0xffff0000, v135
  v_fmac_f32_dpp v70, v28, v86 row_newbcast:0 row_mask:0xf bank_mask:0xf
  v_fmac_f32_dpp v78, v28, v86 row_newbcast:1 row_mask:0xf bank_mask:0xf
  v_fmac_f32_dpp v71, v28, v87 row_newbcast:0 row_mask:0xf bank_mask:0xf
  v_fmac_f32_dpp v79, v28, v87 row_newbcast:1 row_mask:0xf bank_mask:0xf
  v_fmac_f32_dpp v72, v28, v88 row_newbcast:0 row_mask:0xf bank_mask:0xf
  v_fmac_f32_dpp v80, v28, v88 row_newbcast:1 row_mask:0xf bank_mask:0xf
  v_fmac_f32_dpp v73, v28, v89 row_newbcast:0 row_mask:0xf bank_mask:0xf
  v_fmac_f32_dpp v81, v28, v89 row_newbcast:1 row_mask:0xf bank_mask:0xf
  v_fmac_f32_dpp v74, v28, v90 row_newbcast:0 row_mask:0xf bank_mask:0xf
  v_fmac_f32_dpp v82, v28, v90 row_newbcast:1 row_mask:0xf bank_mask:0xf
  v_fmac_f32_dpp v75, v28, v91 row_newbcast:0 row_mask:0xf bank_mask:0xf
  v_fmac_f32_dpp v83, v28, v91 row_newbcast:1 row_mask:0xf bank_mask:0xf
  v_fmac_f32_dpp v76, v28, v92 row_newbcast:0 row_mask:0xf bank_mask:0xf
  v_fmac_f32_dpp v84, v28, v92 row_newbcast:1 row_mask:0xf bank_mask:0xf
  v_fmac_f32_dpp v77, v28, v93 row_newbcast:0 row_mask:0xf bank_mask:0xf
  v_fmac_f32_dpp v85, v28, v93 row_newbcast:1 row_mask:0xf bank_mask:0xf
  s_waitcnt vmcnt(6)
  v_lshlrev_b32 v86, 16, v136
  v_and_b32 v87, 0xffff0000, v136
  v_lshlrev_b32 v88, 16, v137
  v_and_b32 v89, 0xffff0000, v137
  v_lshlrev_b32 v90, 16, v138
  v_and_b32 v91, 0xffff0000, v138
  v_lshlrev_b32 v92, 16, v139
  v_and_b32 v93, 0xffff0000, v139
  v_fmac_f32_dpp v70, v29, v86 row_newbcast:0 row_mask:0xf bank_mask:0xf
  v_fmac_f32_dpp v78, v29, v86 row_newbcast:1 row_mask:0xf bank_mask:0xf
  v_fmac_f32_dpp v71, v29, v87 row_newbcast:0 row_mask:0xf bank_mask:0xf
  v_fmac_f32_dpp v79, v29, v87 row_newbcast:1 row_mask:0xf bank_mask:0xf
  v_fmac_f32_dpp v72, v29, v88 row_newbcast:0 row_mask:0xf bank_mask:0xf
  v_fmac_f32_dpp v80, v29, v88 row_newbcast:1 row_mask:0xf bank_mask:0xf
  v_fmac_f32_dpp v73, v29, v89 row_newbcast:0 row_mask:0xf bank_mask:0xf
  v_fmac_f32_dpp v81, v29, v89 row_newbcast:1 row_mask:0xf bank_mask:0xf
  v_fmac_f32_dpp v74, v29, v90 row_newbcast:0 row_mask:0xf bank_mask:0xf
  v_fmac_f32_dpp v82, v29, v90 row_newbcast:1 row_mask:0xf bank_mask:0xf
  v_fmac_f32_dpp v75, v29, v91 row_newbcast:0 row_mask:0xf bank_mask:0xf
  v_fmac_f32_dpp v83, v29, v91 row_newbcast:1 row_mask:0xf bank_mask:0xf
  v_fmac_f32_dpp v76, v29, v92 row_newbcast:0 row_mask:0xf bank_mask:0xf
  v_fmac_f32_dpp v84, v29, v92 row_newbcast:1 row_mask:0xf bank_mask:0xf
  v_fmac_f32_dpp v77, v29, v93 row_newbcast:0 row_mask:0xf bank_mask:0xf
  v_fmac_f32_dpp v85, v29, v93 row_newbcast:1 row_mask:0xf bank_mask:0xf
  s_waitcnt vmcnt(5)
  v_lshlrev_b32 v86, 16, v140
  v_and_b32 v87, 0xffff0000, v140
  v_lshlrev_b32 v88, 16, v141
  v_and_b32 v89, 0xffff0000, v141
  v_lshlrev_b32 v90, 16, v142
  v_and_b32 v91, 0xffff0000, v142
  v_lshlrev_b32 v92, 16, v143
  v_and_b32 v93, 0xffff0000, v143
  v_fmac_f32_dpp v70, v30, v86 row_newbcast:0 row_mask:0xf bank_mask:0xf
  v_fmac_f32_dpp v78, v30, v86 row_newbcast:1 row_mask:0xf bank_mask:0xf
  v_fmac_f32_dpp v71, v30, v87 row_newbcast:0 row_mask:0xf bank_mask:0xf
  v_fmac_f32_dpp v79, v30, v87 row_newbcast:1 row_mask:0xf bank_mask:0xf
  v_fmac_f32_dpp v72, v30, v88 row_newbcast:0 row_mask:0xf bank_mask:0xf
  v_fmac_f32_dpp v80, v30, v88 row_newbcast:1 row_mask:0xf bank_mask:0xf
  v_fmac_f32_dpp v73, v30, v89 row_newbcast:0 row_mask:0xf bank_mask:0xf
  v_fmac_f32_dpp v81, v30, v89 row_newbcast:1 row_mask:0xf bank_mask:0xf
  v_fmac_f32_dpp v74, v30, v90 row_newbcast:0 row_mask:0xf bank_mask:0xf
  v_fmac_f32_dpp v82, v30, v90 row_newbcast:1 row_mask:0xf bank_mask:0xf
  v_fmac_f32_dpp v75, v30, v91 row_newbcast:0 row_mask:0xf bank_mask:0xf
  v_fmac_f32_dpp v83, v30, v91 row_newbcast:1 row_mask:0xf bank_mask:0xf
  v_fmac_f32_dpp v76, v30, v92 row_newbcast:0 row_mask:0xf bank_mask:0xf
  v_fmac_f32_dpp v84, v30, v92 row_newbcast:1 row_mask:0xf bank_mask:0xf
  v_fmac_f32_dpp v77, v30, v93 row_newbcast:0 row_mask:0xf bank_mask:0xf
  v_fmac_f32_dpp v85, v30, v93 row_newbcast:1 row_mask:0xf bank_mask:0xf
  s_waitcnt vmcnt(4)
  v_lshlrev_b32 v86, 16, v144
  v_and_b32 v87, 0xffff0000, v144
  v_lshlrev_b32 v88, 16, v145
  v_and_b32 v89, 0xffff0000, v145
  v_lshlrev_b32 v90, 16, v146
  v_and_b32 v91, 0xffff0000, v146
  v_lshlrev_b32 v92, 16, v147
  v_and_b32 v93, 0xffff0000, v147
  v_fmac_f32_dpp v70, v31, v86 row_newbcast:0 row_mask:0xf bank_mask:0xf
  v_fmac_f32_dpp v78, v31, v86 row_newbcast:1 row_mask:0xf bank_mask:0xf
  v_fmac_f32_dpp v71, v31, v87 row_newbcast:0 row_mask:0xf bank_mask:0xf
  v_fmac_f32_dpp v79, v31, v87 row_newbcast:1 row_mask:0xf bank_mask:0xf
  v_fmac_f32_dpp v72, v31, v88 row_newbcast:0 row_mask:0xf bank_mask:0xf
  v_fmac_f32_dpp v80, v31, v88 row_newbcast:1 row_mask:0xf bank_mask:0xf
  v_fmac_f32_dpp v73, v31, v89 row_newbcast:0 row_mask:0xf bank_mask:0xf
  v_fmac_f32_dpp v81, v31, v89 row_newbcast:1 row_mask:0xf bank_mask:0xf
  v_fmac_f32_dpp v74, v31, v90 row_newbcast:0 row_mask:0xf bank_mask:0xf
  v_fmac_f32_dpp v82, v31, v90 row_newbcast:1 row_mask:0xf bank_mask:0xf
  v_fmac_f32_dpp v75, v31, v91 row_newbcast:0 row_mask:0xf bank_mask:0xf
  v_fmac_f32_dpp v83, v31, v91 row_newbcast:1 row_mask:0xf bank_mask:0xf
  v_fmac_f32_dpp v76, v31, v92 row_newbcast:0 row_mask:0xf bank_mask:0xf
  v_fmac_f32_dpp v84, v31, v92 row_newbcast:1 row_mask:0xf bank_mask:0xf
  v_fmac_f32_dpp v77, v31, v93 row_newbcast:0 row_mask:0xf bank_mask:0xf
  v_fmac_f32_dpp v85, v31, v93 row_newbcast:1 row_mask:0xf bank_mask:0xf
  s_waitcnt vmcnt(3)
  v_lshlrev_b32 v86, 16, v148
  v_and_b32 v87, 0xffff0000, v148
  v_lshlrev_b32 v88, 16, v149
  v_and_b32 v89, 0xffff0000, v149
  v_lshlrev_b32 v90, 16, v150
  v_and_b32 v91, 0xffff0000, v150
  v_lshlrev_b32 v92, 16, v151
  v_and_b32 v93, 0xffff0000, v151
  v_fmac_f32_dpp v70, v32, v86 row_newbcast:0 row_mask:0xf bank_mask:0xf
  v_fmac_f32_dpp v78, v32, v86 row_newbcast:1 row_mask:0xf bank_mask:0xf
  v_fmac_f32_dpp v71, v32, v87 row_newbcast:0 row_mask:0xf bank_mask:0xf
  v_fmac_f32_dpp v79, v32, v87 row_newbcast:1 row_mask:0xf bank_mask:0xf
  v_fmac_f32_dpp v72, v32, v88 row_newbcast:0 row_mask:0xf bank_mask:0xf
  v_fmac_f32_dpp v80, v32, v88 row_newbcast:1 row_mask:0xf bank_mask:0xf
  v_fmac_f32_dpp v73, v32, v89 row_newbcast:0 row_mask:0xf bank_mask:0xf
  v_fmac_f32_dpp v81, v32, v89 row_newbcast:1 row_mask:0xf bank_mask:0xf
  v_fmac_f32_dpp v74, v32, v90 row_newbcast:0 row_mask:0xf bank_mask:0xf
  v_fmac_f32_dpp v82, v32, v90 row_newbcast:1 row_mask:0xf bank_mask:0xf
  v_fmac_f32_dpp v75, v32, v91 row_newbcast:0 row_mask:0xf bank_mask:0xf
  v_fmac_f32_dpp v83, v32, v91 row_newbcast:1 row_mask:0xf bank_mask:0xf
  v_fmac_f32_dpp v76, v32, v92 row_newbcast:0 row_mask:0xf bank_mask:0xf
  v_fmac_f32_dpp v84, v32, v92 row_newbcast:1 row_mask:0xf bank_mask:0xf
  v_fmac_f32_dpp v77, v32, v93 row_newbcast:0 row_mask:0xf bank_mask:0xf
  v_fmac_f32_dpp v85, v32, v93 row_newbcast:1 row_mask:0xf bank_mask:0xf
  s_waitcnt vmcnt(2)
  v_lshlrev_b32 v86, 16, v152
  v_and_b32 v87, 0xffff0000, v152
  v_lshlrev_b32 v88, 16, v153
  v_and_b32 v89, 0xffff0000, v153
  v_lshlrev_b32 v90, 16, v154
  v_and_b32 v91, 0xffff0000, v154
  v_lshlrev_b32 v92, 16, v155
  v_and_b32 v93, 0xffff0000, v155
  v_fmac_f32_dpp v70, v33, v86 row_newbcast:0 row_mask:0xf bank_mask:0xf
  v_fmac_f32_dpp v78, v33, v86 row_newbcast:1 row_mask:0xf bank_mask:0xf
  v_fmac_f32_dpp v71, v33, v87 row_newbcast:0 row_mask:0xf bank_mask:0xf
  v_fmac_f32_dpp v79, v33, v87 row_newbcast:1 row_mask:0xf bank_mask:0xf
  v_fmac_f32_dpp v72, v33, v88 row_newbcast:0 row_mask:0xf bank_mask:0xf
  v_fmac_f32_dpp v80, v33, v88 row_newbcast:1 row_mask:0xf bank_mask:0xf
  v_fmac_f32_dpp v73, v33, v89 row_newbcast:0 row_mask:0xf bank_mask:0xf
  v_fmac_f32_dpp v81, v33, v89 row_newbcast:1 row_mask:0xf bank_mask:0xf
  v_fmac_f32_dpp v74, v33, v90 row_newbcast:0 row_mask:0xf bank_mask:0xf
  v_fmac_f32_dpp v82, v33, v90 row_newbcast:1 row_mask:0xf bank_mask:0xf
  v_fmac_f32_dpp v75, v33, v91 row_newbcast:0 row_mask:0xf bank_mask:0xf
  v_fmac_f32_dpp v83, v33, v91 row_newbcast:1 row_mask:0xf bank_mask:0xf
  v_fmac_f32_dpp v76, v33, v92 row_newbcast:0 row_mask:0xf bank_mask:0xf
  v_fmac_f32_dpp v84, v33, v92 row_newbcast:1 row_mask:0xf bank_mask:0xf
  v_fmac_f32_dpp v77, v33, v93 row_newbcast:0 row_mask:0xf bank_mask:0xf
  v_fmac_f32_dpp v85, v33, v93 row_newbcast:1 row_mask:0xf bank_mask:0xf
  s_waitcnt vmcnt(1)
  v_lshlrev_b32 v86, 16, v156
  v_and_b32 v87, 0xffff0000, v156
  v_lshlrev_b32 v88, 16, v157
  v_and_b32 v89, 0xffff0000, v157
  v_lshlrev_b32 v90, 16, v158
  v_and_b32 v91, 0xffff0000, v158
  v_lshlrev_b32 v92, 16, v159
  v_and_b32 v93, 0xffff0000, v159
  v_fmac_f32_dpp v70, v34, v86 row_newbcast:0 row_mask:0xf bank_mask:0xf
  v_fmac_f32_dpp v78, v34, v86 row_newbcast:1 row_mask:0xf bank_mask:0xf
  v_fmac_f32_dpp v71, v34, v87 row_newbcast:0 row_mask:0xf bank_mask:0xf
  v_fmac_f32_dpp v79, v34, v87 row_newbcast:1 row_mask:0xf bank_mask:0xf
  v_fmac_f32_dpp v72, v34, v88 row_newbcast:0 row_mask:0xf bank_mask:0xf
  v_fmac_f32_dpp v80, v34, v88 row_newbcast:1 row_mask:0xf bank_mask:0xf
  v_fmac_f32_dpp v73, v34, v89 row_newbcast:0 row_mask:0xf bank_mask:0xf
  v_fmac_f32_dpp v81, v34, v89 row_newbcast:1 row_mask:0xf bank_mask:0xf
  v_fmac_f32_dpp v74, v34, v90 row_newbcast:0 row_mask:0xf bank_mask:0xf
  v_fmac_f32_dpp v82, v34, v90 row_newbcast:1 row_mask:0xf bank_mask:0xf
  v_fmac_f32_dpp v75, v34, v91 row_newbcast:0 row_mask:0xf bank_mask:0xf
  v_fmac_f32_dpp v83, v34, v91 row_newbcast:1 row_mask:0xf bank_mask:0xf
  v_fmac_f32_dpp v76, v34, v92 row_newbcast:0 row_mask:0xf bank_mask:0xf
  v_fmac_f32_dpp v84, v34, v92 row_newbcast:1 row_mask:0xf bank_mask:0xf
  v_fmac_f32_dpp v77, v34, v93 row_newbcast:0 row_mask:0xf bank_mask:0xf
  v_fmac_f32_dpp v85, v34, v93 row_newbcast:1 row_mask:0xf bank_mask:0xf
  s_waitcnt vmcnt(0)
  v_lshlrev_b32 v86, 16, v160
  v_and_b32 v87, 0xffff0000, v160
  v_lshlrev_b32 v88, 16, v161
  v_and_b32 v89, 0xffff0000, v161
  v_lshlrev_b32 v90, 16, v162
  v_and_b32 v91, 0xffff0000, v162
  v_lshlrev_b32 v92, 16, v163
  v_and_b32 v93, 0xffff0000, v163
  v_fmac_f32_dpp v70, v35, v86 row_newbcast:0 row_mask:0xf bank_mask:0xf
  v_fmac_f32_dpp v78, v35, v86 row_newbcast:1 row_mask:0xf bank_mask:0xf
  v_fmac_f32_dpp v71, v35, v87 row_newbcast:0 row_mask:0xf bank_mask:0xf
  v_fmac_f32_dpp v79, v35, v87 row_newbcast:1 row_mask:0xf bank_mask:0xf
  v_fmac_f32_dpp v72, v35, v88 row_newbcast:0 row_mask:0xf bank_mask:0xf
  v_fmac_f32_dpp v80, v35, v88 row_newbcast:1 row_mask:0xf bank_mask:0xf
  v_fmac_f32_dpp v73, v35, v89 row_newbcast:0 row_mask:0xf bank_mask:0xf
  v_fmac_f32_dpp v81, v35, v89 row_newbcast:1 row_mask:0xf bank_mask:0xf
  v_fmac_f32_dpp v74, v35, v90 row_newbcast:0 row_mask:0xf bank_mask:0xf
  v_fmac_f32_dpp v82, v35, v90 row_newbcast:1 row_mask:0xf bank_mask:0xf
  v_fmac_f32_dpp v75, v35, v91 row_newbcast:0 row_mask:0xf bank_mask:0xf
  v_fmac_f32_dpp v83, v35, v91 row_newbcast:1 row_mask:0xf bank_mask:0xf
  v_fmac_f32_dpp v76, v35, v92 row_newbcast:0 row_mask:0xf bank_mask:0xf
  v_fmac_f32_dpp v84, v35, v92 row_newbcast:1 row_mask:0xf bank_mask:0xf
  v_fmac_f32_dpp v77, v35, v93 row_newbcast:0 row_mask:0xf bank_mask:0xf
  v_fmac_f32_dpp v85, v35, v93 row_newbcast:1 row_mask:0xf bank_mask:0xf
  buffer_load_dword v36, v99, s[56:59], s8 offen offset:0 nt
  buffer_load_dword v37, v99, s[56:59], s8 offen offset:1152 nt
  buffer_load_dword v38, v99, s[56:59], s8 offen offset:2304 nt
  s_add_u32 s8, s8, 3456
  buffer_load_dword v39, v99, s[56:59], s8 offen offset:0 nt
  buffer_load_dword v40, v99, s[56:59], s8 offen offset:1152 nt
  buffer_load_dword v41, v99, s[56:59], s8 offen offset:2304 nt
  s_add_u32 s8, s8, 3456
  buffer_load_dword v42, v99, s[56:59], s8 offen offset:0 nt
  buffer_load_dword v43, v99, s[56:59], s8 offen offset:1152 nt
  buffer_load_dword v44, v99, s[56:59], s8 offen offset:2304 nt
  s_add_u32 s8, s8, 3456
  buffer_load_dword v45, v99, s[56:59], s8 offen offset:0 nt
  buffer_load_dword v46, v99, s[56:59], s8 offen offset:1152 nt
  buffer_load_dword v47, v99, s[56:59], s8 offen offset:2304 nt
  s_add_u32 s8, s8, 3456
  buffer_load_dword v48, v99, s[56:59], s8 offen offset:0 nt
  buffer_load_dword v49, v99, s[56:59], s8 offen offset:1152 nt
  buffer_load_dword v50, v99, s[56:59], s8 offen offset:2304 nt
  s_add_u32 s8, s8, 3456
  buffer_load_dword v51, v99, s[56:59], s8 offen offset:0 nt
  buffer_load_dword v52, v99, s[56:59], s8 offen offset:1152 nt
  buffer_load_dword v53, v99, s[56:59], s8 offen offset:2304 nt
  buffer_load_dword v54, v99, s[44:47], s9 offen offset:0 nt
  buffer_load_dword v55, v99, s[44:47], s9 offen offset:1152 nt
  buffer_load_dword v56, v99, s[44:47], s9 offen offset:2304 nt
  s_add_u32 s9, s9, 3456
  buffer_load_dword v57, v99, s[44:47], s9 offen offset:0 nt
  buffer_load_dword v58, v99, s[44:47], s9 offen offset:1152 nt
  buffer_load_dword v59, v99, s[44:47], s9 offen offset:2304 nt
  s_add_u32 s9, s9, 3456
  buffer_load_dword v60, v99, s[44:47], s9 offen offset:0 nt
  buffer_load_dword v61, v99, s[44:47], s9 offen offset:1152 nt
  buffer_load_dword v62, v99, s[44:47], s9 offen offset:2304 nt
  s_add_u32 s9, s9, 3456
  buffer_load_dword v63, v99, s[44:47], s9 offen offset:0 nt
  buffer_load_dword v64, v99, s[44:47], s9 offen offset:1152 nt
  buffer_load_dword v65, v99, s[44:47], s9 offen offset:2304 nt
  s_add_u32 s9, s9, 3456
  buffer_load_dword v66, v99, s[44:47], s9 offen offset:0 nt
  buffer_load_dword v67, v99, s[44:47], s9 offen offset:1152 nt
  buffer_load_dword v68, v99, s[44:47], s9 offen offset:2304 nt
  s_add_u32 s9, s9, 3456
  buffer_load_dword v69, v99, s[44:47], s9 offen offset:0 nt
  s_nop 1
  v_permlane32_swap_b32 v70, v78
  v_permlane32_swap_b32 v71, v79
  v_permlane32_swap_b32 v72, v80
  v_permlane32_swap_b32 v73, v81
  v_permlane32_swap_b32 v74, v82
  v_permlane32_swap_b32 v75, v83
  v_permlane32_swap_b32 v76, v84
  v_permlane32_swap_b32 v77, v85
  s_nop 1
  v_add_f32 v70, v70, v78
  v_add_f32 v71, v71, v79
  v_add_f32 v72, v72, v80
  v_add_f32 v73, v73, v81
  v_add_f32 v74, v74, v82
  v_add_f32 v75, v75, v83
  v_add_f32 v76, v76, v84
  v_add_f32 v77, v77, v85
  s_nop 1
  v_permlane16_swap_b32 v70, v74
  v_permlane16_swap_b32 v71, v75
  v_permlane16_swap_b32 v72, v76
  v_permlane16_swap_b32 v73, v77
  s_nop 1
  v_add_f32 v70, v70, v74
  v_add_f32 v71, v71, v75
  v_add_f32 v72, v72, v76
  v_add_f32 v73, v73, v77
  ds_write_b128 v4, v[70:73] offset:22592
  s_waitcnt lgkmcnt(0)
  s_mov_b64 exec, 1
  ds_add_rtn_u32 v164, v3, v96 offset:16
  s_waitcnt lgkmcnt(0)
  v_readfirstlane_b32 s99, v164
  s_mov_b64 exec, -1
  s_cmp_lg_u32 s99, 7
  s_cbranch_scc1 L_kv_late
  ds_read_b64 v[132:133], v7 offset:1408
  ds_read_b64 v[134:135], v7 offset:1424
  ds_read_b64 v[136:137], v7 offset:1440
  ds_read_b64 v[138:139], v7 offset:1456
  ds_read_b64 v[140:141], v7 offset:1472
  ds_read_b64 v[142:143], v7 offset:1488
  ds_read_b64 v[144:145], v7 offset:1504
  ds_read_b64 v[146:147], v7 offset:1520
  ds_read_b128 v[100:103], v6 offset:22592
  ds_read_b128 v[104:107], v6 offset:23616
  ds_read_b128 v[108:111], v6 offset:24640
  ds_read_b128 v[112:115], v6 offset:25664
  ds_read_b128 v[116:119], v6 offset:26688
  ds_read_b128 v[120:123], v6 offset:27712
  ds_read_b128 v[124:127], v6 offset:28736
  ds_read_b128 v[128:131], v6 offset:29760
  s_waitcnt lgkmcnt(8)
  v_max3_f32 v148, v132, v134, v136
  v_max3_f32 v148, v148, v138, v140
  v_max3_f32 v148, v148, v142, v144
  v_max_f32 v148, v148, v146
  v_bfi_b32 v148, s31, v97, v148
  v_sub_f32 v132, v132, v148
  v_sub_f32 v134, v134, v148
  v_sub_f32 v136, v136, v148
  v_sub_f32 v138, v138, v148
  v_sub_f32 v140, v140, v148
  v_sub_f32 v142, v142, v148
  v_sub_f32 v144, v144, v148
  v_sub_f32 v146, v146, v148
  v_exp_f32 v132, v132
  v_exp_f32 v134, v134
  v_exp_f32 v136, v136
  v_exp_f32 v138, v138
  v_exp_f32 v140, v140
  v_exp_f32 v142, v142
  v_exp_f32 v144, v144
  v_exp_f32 v146, v146
  s_nop 0
  v_mul_f32 v149, v132, v133
  v_fmac_f32 v149, v134, v135
  v_fmac_f32 v149, v136, v137
  v_fmac_f32 v149, v138, v139
  v_fmac_f32 v149, v140, v141
  v_fmac_f32 v149, v142, v143
  v_fmac_f32 v149, v144, v145
  v_fmac_f32 v149, v146, v147
  s_waitcnt lgkmcnt(7)
  v_mul_f32 v100, v132, v100
  v_mul_f32 v101, v132, v101
  v_mul_f32 v102, v132, v102
  v_mul_f32 v103, v132, v103
  s_waitcnt lgkmcnt(6)
  v_fmac_f32 v100, v134, v104
  v_fmac_f32 v101, v134, v105
  v_fmac_f32 v102, v134, v106
  v_fmac_f32 v103, v134, v107
  s_waitcnt lgkmcnt(5)
  v_fmac_f32 v100, v136, v108
  v_fmac_f32 v101, v136, v109
  v_fmac_f32 v102, v136, v110
  v_fmac_f32 v103, v136, v111
  s_waitcnt lgkmcnt(4)
  v_fmac_f32 v100, v138, v112
  v_fmac_f32 v101, v138, v113
  v_fmac_f32 v102, v138, v114
  v_fmac_f32 v103, v138, v115
  s_waitcnt lgkmcnt(3)
  v_fmac_f32 v100, v140, v116
  v_fmac_f32 v101, v140, v117
  v_fmac_f32 v102, v140, v118
  v_fmac_f32 v103, v140, v119
  s_waitcnt lgkmcnt(2)
  v_fmac_f32 v100, v142, v120
  v_fmac_f32 v101, v142, v121
  v_fmac_f32 v102, v142, v122
  v_fmac_f32 v103, v142, v123
  s_waitcnt lgkmcnt(1)
  v_fmac_f32 v100, v144, v124
  v_fmac_f32 v101, v144, v125
  v_fmac_f32 v102, v144, v126
  v_fmac_f32 v103, v144, v127
  s_waitcnt lgkmcnt(0)
  v_fmac_f32 v100, v146, v128
  v_fmac_f32 v101, v146, v129
  v_fmac_f32 v102, v146, v130
  v_fmac_f32 v103, v146, v131
  v_bfi_b32 v100, s31, v97, v100
  v_bfi_b32 v101, s31, v97, v101
  v_bfi_b32 v102, s31, v97, v102
  v_bfi_b32 v103, s31, v97, v103
  v_bfi_b32 v149, s31, v97, v149
  v_mov_b32 v150, v97
  v_mov_b32 v151, v97
  buffer_store_dwordx4 v[100:103], v6, s[60:63], s10 offen sc1
  s_mov_b32 exec_lo, 1
  s_mov_b32 exec_hi, 1
  buffer_store_dwordx4 v[148:151], v9, s[60:63], s10 offen offset:1024 sc1
  s_mov_b64 exec, -1
L_kv_late:
  s_cmp_ge_u32 s15, 5
  s_cbranch_scc1 L_kv_end
  s_mov_b32 s98, 0
W_4:
  ds_read_b32 v164, v3 offset:12
  s_waitcnt lgkmcnt(0)
  v_readfirstlane_b32 s99, v164
  s_cmp_ge_u32 s99, 1
  s_cbranch_scc1 WD_5
  s_sleep 1
  s_add_u32 s98, s98, 1
  s_cmp_lt_u32 s98, 1048576
  s_cbranch_scc1 W_4
WD_5:
L_skipH:
  ds_read_b128 v[104:107], v3 offset:320
  ds_read_b128 v[108:111], v3 offset:336
  ds_read_b128 v[112:115], v3 offset:352
  ds_read_b128 v[116:119], v3 offset:368
  ds_read_b128 v[120:123], v3 offset:384
  ds_read_b128 v[128:131], v3 offset:416
  ds_read_b128 v[132:135], v3 offset:432
  ds_read_b128 v[136:139], v3 offset:448
  ds_read_b128 v[140:143], v3 offset:464
  ds_read_b128 v[144:147], v3 offset:480
  s_waitcnt vmcnt(16) lgkmcnt(0)
  v_lshlrev_b32 v164, 16, v36
  v_and_b32 v165, 0xffff0000, v36
  v_mul_f32 v10, v104, v164
  v_mul_f32 v11, v104, v165
  v_mul_f32 v12, v128, v164
  v_mul_f32 v13, v128, v165
  v_lshlrev_b32 v164, 16, v37
  v_and_b32 v165, 0xffff0000, v37
  v_fmac_f32 v10, v105, v164
  v_fmac_f32 v11, v105, v165
  v_fmac_f32 v12, v129, v164
  v_fmac_f32 v13, v129, v165
  v_lshlrev_b32 v164, 16, v38
  v_and_b32 v165, 0xffff0000, v38
  v_fmac_f32 v10, v106, v164
  v_fmac_f32 v11, v106, v165
  v_fmac_f32 v12, v130, v164
  v_fmac_f32 v13, v130, v165
  v_lshlrev_b32 v164, 16, v39
  v_and_b32 v165, 0xffff0000, v39
  v_fmac_f32 v10, v107, v164
  v_fmac_f32 v11, v107, v165
  v_fmac_f32 v12, v131, v164
  v_fmac_f32 v13, v131, v165
  v_lshlrev_b32 v164, 16, v40
  v_and_b32 v165, 0xffff0000, v40
  v_fmac_f32 v10, v108, v164
  v_fmac_f32 v11, v108, v165
  v_fmac_f32 v12, v132, v164
  v_fmac_f32 v13, v132, v165
  v_lshlrev_b32 v164, 16, v41
  v_and_b32 v165, 0xffff0000, v41
  v_fmac_f32 v10, v109, v164
  v_fmac_f32 v11, v109, v165
  v_fmac_f32 v12, v133, v164
  v_fmac_f32 v13, v133, v165
  v_lshlrev_b32 v164, 16, v42
  v_and_b32 v165, 0xffff0000, v42
  v_fmac_f32 v10, v110, v164
  v_fmac_f32 v11, v110, v165
  v_fmac_f32 v12, v134, v164
  v_fmac_f32 v13, v134, v165
  v_lshlrev_b32 v164, 16, v43
  v_and_b32 v165, 0xffff0000, v43
  v_fmac_f32 v10, v111, v164
  v_fmac_f32 v11, v111, v165
  v_fmac_f32 v12, v135, v164
  v_fmac_f32 v13, v135, v165
  v_lshlrev_b32 v164, 16, v44
  v_and_b32 v165, 0xffff0000, v44
  v_fmac_f32 v10, v112, v164
  v_fmac_f32 v11, v112, v165
  v_fmac_f32 v12, v136, v164
  v_fmac_f32 v13, v136, v165
  v_lshlrev_b32 v164, 16, v45
  v_and_b32 v165, 0xffff0000, v45
  v_fmac_f32 v10, v113, v164
  v_fmac_f32 v11, v113, v165
  v_fmac_f32 v12, v137, v164
  v_fmac_f32 v13, v137, v165
  v_lshlrev_b32 v164, 16, v46
  v_and_b32 v165, 0xffff0000, v46
  v_fmac_f32 v10, v114, v164
  v_fmac_f32 v11, v114, v165
  v_fmac_f32 v12, v138, v164
  v_fmac_f32 v13, v138, v165
  v_lshlrev_b32 v164, 16, v47
  v_and_b32 v165, 0xffff0000, v47
  v_fmac_f32 v10, v115, v164
  v_fmac_f32 v11, v115, v165
  v_fmac_f32 v12, v139, v164
  v_fmac_f32 v13, v139, v165
  v_lshlrev_b32 v164, 16, v48
  v_and_b32 v165, 0xffff0000, v48
  v_fmac_f32 v10, v116, v164
  v_fmac_f32 v11, v116, v165
  v_fmac_f32 v12, v140, v164
  v_fmac_f32 v13, v140, v165
  v_lshlrev_b32 v164, 16, v49
  v_and_b32 v165, 0xffff0000, v49
  v_fmac_f32 v10, v117, v164
  v_fmac_f32 v11, v117, v165
  v_fmac_f32 v12, v141, v164
  v_fmac_f32 v13, v141, v165
  v_lshlrev_b32 v164, 16, v50
  v_and_b32 v165, 0xffff0000, v50
  v_fmac_f32 v10, v118, v164
  v_fmac_f32 v11, v118, v165
  v_fmac_f32 v12, v142, v164
  v_fmac_f32 v13, v142, v165
  v_lshlrev_b32 v164, 16, v51
  v_and_b32 v165, 0xffff0000, v51
  v_fmac_f32 v10, v119, v164
  v_fmac_f32 v11, v119, v165
  v_fmac_f32 v12, v143, v164
  v_fmac_f32 v13, v143, v165
  v_lshlrev_b32 v164, 16, v52
  v_and_b32 v165, 0xffff0000, v52
  v_fmac_f32 v10, v120, v164
  v_fmac_f32 v11, v120, v165
  v_fmac_f32 v12, v144, v164
  v_fmac_f32 v13, v144, v165
  v_lshlrev_b32 v164, 16, v53
  v_and_b32 v165, 0xffff0000, v53
  v_fmac_f32 v10, v121, v164
  v_fmac_f32 v11, v121, v165
  v_fmac_f32 v12, v145, v164
  v_fmac_f32 v13, v145, v165
  s_waitcnt vmcnt(0)
  v_lshlrev_b32 v36, 16, v54
  v_and_b32 v54, 0xffff0000, v54
  v_lshlrev_b32 v37, 16, v55
  v_and_b32 v55, 0xffff0000, v55
  v_lshlrev_b32 v38, 16, v56
  v_and_b32 v56, 0xffff0000, v56
  v_lshlrev_b32 v39, 16, v57
  v_and_b32 v57, 0xffff0000, v57
  v_lshlrev_b32 v40, 16, v58
  v_and_b32 v58, 0xffff0000, v58
  v_lshlrev_b32 v41, 16, v59
  v_and_b32 v59, 0xffff0000, v59
  v_lshlrev_b32 v42, 16, v60
  v_and_b32 v60, 0xffff0000, v60
  v_lshlrev_b32 v43, 16, v61
  v_and_b32 v61, 0xffff0000, v61
  v_lshlrev_b32 v44, 16, v62
  v_and_b32 v62, 0xffff0000, v62
  v_lshlrev_b32 v45, 16, v63
  v_and_b32 v63, 0xffff0000, v63
  v_lshlrev_b32 v46, 16, v64
  v_and_b32 v64, 0xffff0000, v64
  v_lshlrev_b32 v47, 16, v65
  v_and_b32 v65, 0xffff0000, v65
  v_lshlrev_b32 v48, 16, v66
  v_and_b32 v66, 0xffff0000, v66
  v_lshlrev_b32 v49, 16, v67
  v_and_b32 v67, 0xffff0000, v67
  v_lshlrev_b32 v50, 16, v68
  v_and_b32 v68, 0xffff0000, v68
  v_lshlrev_b32 v51, 16, v69
  v_and_b32 v69, 0xffff0000, v69
  s_mov_b32 s98, 0
W_6:
  ds_read_b32 v164, v3 offset:20
  s_waitcnt lgkmcnt(0)
  v_readfirstlane_b32 s99, v164
  s_cmp_ge_u32 s99, 1
  s_cbranch_scc1 WD_7
  s_add_u32 s98, s98, 1
  s_cmp_lt_u32 s98, 1048576
  s_cbranch_scc1 W_6
WD_7:
L_skipO:
  ds_read_b128 v[104:107], v3 offset:128
  ds_read_b128 v[108:111], v3 offset:144
  ds_read_b128 v[112:115], v3 offset:160
  ds_read_b128 v[116:119], v3 offset:176
  ds_read_b128 v[128:131], v3 offset:224
  ds_read_b128 v[132:135], v3 offset:240
  ds_read_b128 v[136:139], v3 offset:256
  ds_read_b128 v[140:143], v3 offset:272
  s_waitcnt lgkmcnt(7)
  v_fmac_f32 v10, v104, v36
  v_fmac_f32 v11, v104, v54
  v_fmac_f32 v10, v105, v37
  v_fmac_f32 v11, v105, v55
  v_fmac_f32 v10, v106, v38
  v_fmac_f32 v11, v106, v56
  v_fmac_f32 v10, v107, v39
  v_fmac_f32 v11, v107, v57
  s_waitcnt lgkmcnt(6)
  v_fmac_f32 v10, v108, v40
  v_fmac_f32 v11, v108, v58
  v_fmac_f32 v10, v109, v41
  v_fmac_f32 v11, v109, v59
  v_fmac_f32 v10, v110, v42
  v_fmac_f32 v11, v110, v60
  v_fmac_f32 v10, v111, v43
  v_fmac_f32 v11, v111, v61
  s_waitcnt lgkmcnt(5)
  v_fmac_f32 v10, v112, v44
  v_fmac_f32 v11, v112, v62
  v_fmac_f32 v10, v113, v45
  v_fmac_f32 v11, v113, v63
  v_fmac_f32 v10, v114, v46
  v_fmac_f32 v11, v114, v64
  v_fmac_f32 v10, v115, v47
  v_fmac_f32 v11, v115, v65
  s_waitcnt lgkmcnt(4)
  v_fmac_f32 v10, v116, v48
  v_fmac_f32 v11, v116, v66
  v_fmac_f32 v10, v117, v49
  v_fmac_f32 v11, v117, v67
  v_fmac_f32 v10, v118, v50
  v_fmac_f32 v11, v118, v68
  v_fmac_f32 v10, v119, v51
  v_fmac_f32 v11, v119, v69
  s_waitcnt lgkmcnt(3)
  v_fmac_f32 v12, v128, v36
  v_fmac_f32 v13, v128, v54
  v_fmac_f32 v12, v129, v37
  v_fmac_f32 v13, v129, v55
  v_fmac_f32 v12, v130, v38
  v_fmac_f32 v13, v130, v56
  v_fmac_f32 v12, v131, v39
  v_fmac_f32 v13, v131, v57
  s_waitcnt lgkmcnt(2)
  v_fmac_f32 v12, v132, v40
  v_fmac_f32 v13, v132, v58
  v_fmac_f32 v12, v133, v41
  v_fmac_f32 v13, v133, v59
  v_fmac_f32 v12, v134, v42
  v_fmac_f32 v13, v134, v60
  v_fmac_f32 v12, v135, v43
  v_fmac_f32 v13, v135, v61
  s_waitcnt lgkmcnt(1)
  v_fmac_f32 v12, v136, v44
  v_fmac_f32 v13, v136, v62
  v_fmac_f32 v12, v137, v45
  v_fmac_f32 v13, v137, v63
  v_fmac_f32 v12, v138, v46
  v_fmac_f32 v13, v138, v64
  v_fmac_f32 v12, v139, v47
  v_fmac_f32 v13, v139, v65
  s_waitcnt lgkmcnt(0)
  v_fmac_f32 v12, v140, v48
  v_fmac_f32 v13, v140, v66
  v_fmac_f32 v12, v141, v49
  v_fmac_f32 v13, v141, v67
  v_fmac_f32 v12, v142, v50
  v_fmac_f32 v13, v142, v68
  v_fmac_f32 v12, v143, v51
  v_fmac_f32 v13, v143, v69
  v_bfi_b32 v10, s31, v97, v10
  v_bfi_b32 v11, s31, v97, v11
  v_bfi_b32 v12, s31, v97, v12
  v_bfi_b32 v13, s31, v97, v13
  buffer_store_dwordx2 v[10:11], v98, s[60:63], s12 offen sc1
  buffer_store_dwordx2 v[12:13], v98, s[60:63], s12 offen offset:2304 sc1
L_kv_end:
  s_endpgm
L_end:
  s_endpgm
.section .rodata,"a"
.p2align 6
.amdhsa_kernel gated_mix__gqa_block_cached__swiglu_ffn__decode_kernel
  .amdhsa_next_free_vgpr 168
  .amdhsa_next_free_sgpr 102
  .amdhsa_accum_offset 168
  .amdhsa_group_segment_fixed_size 0
  .amdhsa_kernarg_size 104
  .amdhsa_user_sgpr_count 2
  .amdhsa_user_sgpr_kernarg_segment_ptr 1
  .amdhsa_system_sgpr_workgroup_id_x 1
.end_amdhsa_kernel
```
